```python
import torch

def _softmax(x, axis=-1):
    return torch.softmax(x, dim=axis)
def _gelu(x):
    return torch.nn.functional.gelu(x, approximate="tanh")
def _silu(x):
    return torch.nn.functional.silu(x)
def _sigmoid(x):
    return torch.sigmoid(x)
def _layernorm(x, axis=-1, eps=1e-5):
    m = x.mean(dim=axis, keepdim=True)
    v = x.var(dim=axis, keepdim=True, unbiased=False)
    return (x - m) / torch.sqrt(v + eps)
def _scatter_add(tgt, idx, src, axis=0):
    return tgt.clone().index_add_(axis, idx, src)
def _segment_sum(src, seg, n):
    out = torch.zeros((n,) + src.shape[1:], dtype=src.dtype)
    return out.index_add_(0, seg, src)
def _pad(x, pw):
    flat = tuple(v for pair in reversed(pw) for v in pair)
    return torch.nn.functional.pad(x, flat)

kernel_name = 'sequential_preLN__sliding_block_cached__glu_gated_glu__decode'

def setup_inputs():

    _w = (lambda a: (lambda t: t.to(torch.bfloat16) if t.is_floating_point() else t)(torch.as_tensor(a)))
    def _A_setup():
        B, Sq, D = 8, 1, 1024
        Hq, Hkv, Sk, Dh = 32, 4, 4096, 128
        assert Hq % Hkv == 0, (Hq, Hkv)
        return {
            "x": _w((lambda *s: torch.randn(*s, dtype=torch.bfloat16) * 0.05)(B, Sq, D)),
            "k_cache": _w((lambda *s: torch.randn(*s, dtype=torch.bfloat16) * 3.2)(B, Hkv, Sk, Dh)),
            "v_cache": _w((lambda *s: torch.randn(*s, dtype=torch.bfloat16) * 0.4)(B, Hkv, Sk, Dh)),
            "wq": _w((lambda *s: torch.randn(*s, dtype=torch.bfloat16) * 3.2)(D, Hq * Dh) * (D ** -0.5)),
            "wo": _w((lambda *s: torch.randn(*s, dtype=torch.bfloat16) * 0.4)(Hq * Dh, D) * ((Hq * Dh) ** -0.5)),
        }
    _A_in = _A_setup()

    def _B_setup():
        B, S, D, F = 8, 1, 1024, 3584
        return {
            "x": _w((lambda *s: torch.randn(*s, dtype=torch.bfloat16) * 0.05)(B, S, D)),
            "w_gate": _w((lambda *s: torch.randn(*s, dtype=torch.bfloat16) * 0.05)(D, F)),
            "w_up": _w((lambda *s: torch.randn(*s, dtype=torch.bfloat16) * 0.05)(D, F)),
            "w_down": _w((lambda *s: torch.randn(*s, dtype=torch.bfloat16) * 0.05)(F, D)),
        }
    _B_in = _B_setup()

    return {
        "A_x": _A_in["x"],
        "A_k_cache": _A_in["k_cache"],
        "A_v_cache": _A_in["v_cache"],
        "A_wq": _A_in["wq"],
        "A_wo": _A_in["wo"],
        "B_x": _B_in["x"],
        "B_w_gate": _B_in["w_gate"],
        "B_w_up": _B_in["w_up"],
        "B_w_down": _B_in["w_down"],
    }

def reference(A_x, A_k_cache, A_v_cache, A_wq, A_wo, B_x, B_w_gate, B_w_up, B_w_down):
    def _A_ref(x, k_cache, v_cache, wq, wo):
        B, Sq, D = x.shape
        Hq, Dh = 32, 128
        Hkv, Sk = k_cache.shape[1], k_cache.shape[2]
        W = min(4096, max(256, Sk // 4))
        rep = Hq // Hkv
        q = (lambda x, *d: x.permute(*d))((x @ wq).reshape(B, Sq, Hq, Dh), 0, 2, 1, 3)
        k = (lambda x, n, axis: torch.repeat_interleave(x, n, dim=axis))(k_cache[:, :, Sk - W:, :], rep, axis=1)
        v = (lambda x, n, axis: torch.repeat_interleave(x, n, dim=axis))(v_cache[:, :, Sk - W:, :], rep, axis=1)
        scores = torch.einsum("bhqd,bhkd->bhqk", q, k) * (Dh ** -0.5)
        p = _softmax(scores, axis=-1)
        o = torch.einsum("bhqk,bhkd->bhqd", p, v)
        return (lambda x, *d: x.permute(*d))(o, 0, 2, 1, 3).reshape(B, Sq, Hq * Dh) @ wo

    def _B_ref(x, w_gate, w_up, w_down):
        g = torch.einsum("bsd,df->bsf", x, w_gate)
        u = torch.einsum("bsd,df->bsf", x, w_up)
        h = _sigmoid(g) * u
        return torch.einsum("bsf,fd->bsd", h, w_down)

    x = A_x
    h = x + _A_ref(_layernorm(x, axis=-1), A_k_cache, A_v_cache, A_wq, A_wo)
    h2 = h + _B_ref(_layernorm(h, axis=-1), B_w_gate, B_w_up, B_w_down)
    return h2
```

```asm
; @launch grid=(256,1,1) block=(512,1,1) lds=156928
.amdgcn_target "amdgcn-amd-amdhsa--gfx950"
.text
.globl sequential_preLN__sliding_block_cached__glu_gated_glu__decode_kernel
.p2align 8
.type sequential_preLN__sliding_block_cached__glu_gated_glu__decode_kernel,@function
sequential_preLN__sliding_block_cached__glu_gated_glu__decode_kernel:
    s_cmp_ge_u32 s2, 256
    s_cbranch_scc1 L_end
    s_load_dwordx16 s[44:59], s[0:1], 0
    s_load_dwordx8 s[60:67], s[0:1], 64
    v_and_b32 v1, 63, v0
    v_lshrrev_b32 v16, 6, v0
    v_and_b32 v2, 7, v0
    v_bfe_u32 v3, v0, 3, 3
    v_and_b32 v4, 15, v0
    v_bfe_u32 v5, v0, 4, 2
    v_readfirstlane_b32 s3, v16
    v_lshlrev_b32 v8, 4, v1
    v_lshlrev_b32 v12, 3, v1
    v_lshlrev_b32 v13, 2, v1
    s_and_b32 s4, s2, 7
    s_lshr_b32 s5, s2, 3
    s_and_b32 s7, s5, 7
    s_lshr_b32 s71, s5, 1
    s_lshr_b32 s6, s5, 3
    s_and_b32 s84, s3, 3
    s_lshl_b32 s84, s84, 1
    v_and_b32 v19, 1, v5
    v_or_b32 v19, s84, v19
    v_xor_b32 v19, v2, v19
    v_lshlrev_b32 v19, 4, v19
    v_lshl_add_u32 v17, v3, 13, v19
    v_lshlrev_b32 v18, 5, v1
    s_lshr_b32 s85, s2, 6
    s_lshl_b32 s85, s85, 21
    s_lshl_b32 s86, s3, 16
    s_add_u32 s85, s85, s86
    s_and_b32 s86, s2, 63
    s_lshl_b32 s86, s86, 7
    s_add_u32 s85, s85, s86
    s_lshl_b32 s86, s3, 11
    s_lshl_b32 s73, s3, 10
    s_waitcnt lgkmcnt(0)
    s_mov_b32 s8, s44
    s_mov_b32 s9, s45
    s_mov_b32 s10, 16384
    s_mov_b32 s11, 0x20000
    s_mov_b32 s20, s50
    s_mov_b32 s21, s51
    s_mov_b32 s22, 8388608
    s_mov_b32 s23, 0x20000
    buffer_load_dwordx4 v[160:163], v18, s[8:11], s86 offen
    buffer_load_dwordx4 v[164:167], v18, s[8:11], s86 offen offset:16
    s_load_dword s68, s[66:67], 0
    s_barrier
    s_add_u32 m0, s73, 0
    s_add_u32 s84, s85, 0
    buffer_load_dwordx4 v17, s[20:23], s84 offen nt lds
    s_add_u32 m0, s73, 8192
    s_add_u32 s84, s85, 524288
    buffer_load_dwordx4 v17, s[20:23], s84 offen nt lds
    s_add_u32 m0, s73, 16384
    s_add_u32 s84, s85, 1048576
    buffer_load_dwordx4 v17, s[20:23], s84 offen nt lds
    s_add_u32 m0, s73, 24576
    s_add_u32 s84, s85, 1572864
    buffer_load_dwordx4 v17, s[20:23], s84 offen nt lds
    s_mov_b32 s12, s46
    s_mov_b32 s13, s47
    s_mov_b32 s14, 33554432
    s_mov_b32 s15, 0x20000
    s_mov_b32 s16, s48
    s_mov_b32 s17, s49
    s_mov_b32 s18, 33554432
    s_mov_b32 s19, 0x20000
    s_mov_b32 s36, s66
    s_mov_b32 s37, s67
    s_mov_b32 s38, 268435456
    s_mov_b32 s39, 0x20000
    s_lshl_b32 s70, s4, 2
    s_add_u32 s70, s70, s6
    s_lshl_b32 s88, s3, 12
    s_lshl_b32 s72, s70, 20
    s_lshl_b32 s87, s7, 15
    s_add_u32 s72, s72, s87
    s_add_u32 s72, s72, s88
    s_add_u32 s72, s72, 786432
    v_bfe_u32 v22, v0, 2, 2
    v_bfe_u32 v25, v0, 1, 1
    v_lshrrev_b32 v24, 1, v22
    v_lshl_or_b32 v24, v25, 1, v24
    v_and_b32 v26, 1, v5
    v_lshl_or_b32 v24, v26, 2, v24
    v_xor_b32 v24, s3, v24
    v_lshlrev_b32 v24, 4, v24
    v_lshl_add_u32 v24, v22, 7, v24
    v_lshl_add_u32 v24, v25, 10, v24
    v_lshl_add_u32 v24, v5, 11, v24
    v_and_b32 v23, 1, v0
    v_lshl_add_u32 v15, v23, 3, v24
    s_movk_i32 s86, 2112
    v_mul_lo_u32 v7, v2, s86
    v_lshl_add_u32 v7, v3, 4, v7
    v_add_u32 v7, 131072, v7
    s_mul_i32 s84, s3, 2112
    s_add_u32 s84, s84, 131072
    v_add_u32 v207, s84, v12
    v_add_u32 v208, s84, v13
    v_add_u32 v31, s84, v18
    s_lshl_b32 s84, s3, 9
    s_add_u32 s84, s84, 152832
    v_add_u32 v222, s84, v12
    v_lshlrev_b32 v220, 8, v5
    v_lshl_add_u32 v220, v4, 2, v220
    v_add_u32 v220, s84, v220
    v_lshlrev_b32 v221, 7, v5
    v_lshl_add_u32 v221, v2, 2, v221
    v_add_u32 v221, s84, v221
    v_lshlrev_b32 v45, 7, v5
    v_lshl_add_u32 v45, v4, 2, v45
    v_add_u32 v45, s84, v45
    v_xor_b32 v112, v4, v5
    v_lshlrev_b32 v112, 4, v112
    v_lshl_add_u32 v197, v4, 8, v112
    v_add_u32 v197, s88, v197
    v_add_u32 v197, 32768, v197
    v_xor_b32 v198, 64, v197
    v_xor_b32 v199, 128, v197
    v_xor_b32 v200, 192, v197
    v_lshl_add_u32 v112, v5, 8, v112
    v_xor_b32 v113, 64, v112
    v_xor_b32 v114, 128, v112
    v_xor_b32 v115, 192, v112
    v_lshlrev_b32 v212, 1, v5
    v_xor_b32 v212, v4, v212
    v_lshlrev_b32 v212, 4, v212
    v_lshl_add_u32 v212, v5, 8, v212
    v_xor_b32 v213, 128, v212
    s_waitcnt vmcnt(4) lgkmcnt(0)
    v_lshlrev_b32 v144, 16, v160
    v_and_b32 v145, 0xffff0000, v160
    v_readfirstlane_b32 s86, v144
    v_lshlrev_b32 v146, 16, v161
    v_and_b32 v147, 0xffff0000, v161
    v_lshlrev_b32 v148, 16, v162
    v_and_b32 v149, 0xffff0000, v162
    v_lshlrev_b32 v150, 16, v163
    v_and_b32 v151, 0xffff0000, v163
    v_lshlrev_b32 v152, 16, v164
    v_and_b32 v153, 0xffff0000, v164
    v_lshlrev_b32 v154, 16, v165
    v_and_b32 v155, 0xffff0000, v165
    v_lshlrev_b32 v156, 16, v166
    v_and_b32 v157, 0xffff0000, v166
    v_lshlrev_b32 v158, 16, v167
    v_and_b32 v159, 0xffff0000, v167
    s_mov_b32 s87, s86
    v_pk_add_f32 v[16:17], v[144:145], s[86:87] neg_lo:[0,1] neg_hi:[0,1]
    v_pk_mul_f32 v[20:21], v[16:17], v[16:17]
    v_pk_add_f32 v[18:19], v[146:147], s[86:87] neg_lo:[0,1] neg_hi:[0,1]
    v_pk_mul_f32 v[22:23], v[18:19], v[18:19]
    v_pk_add_f32 v[24:25], v[148:149], s[86:87] neg_lo:[0,1] neg_hi:[0,1]
    v_pk_add_f32 v[16:17], v[16:17], v[24:25]
    v_pk_fma_f32 v[20:21], v[24:25], v[24:25], v[20:21]
    v_pk_add_f32 v[26:27], v[150:151], s[86:87] neg_lo:[0,1] neg_hi:[0,1]
    v_pk_add_f32 v[18:19], v[18:19], v[26:27]
    v_pk_fma_f32 v[22:23], v[26:27], v[26:27], v[22:23]
    v_pk_add_f32 v[24:25], v[152:153], s[86:87] neg_lo:[0,1] neg_hi:[0,1]
    v_pk_add_f32 v[16:17], v[16:17], v[24:25]
    v_pk_fma_f32 v[20:21], v[24:25], v[24:25], v[20:21]
    v_pk_add_f32 v[26:27], v[154:155], s[86:87] neg_lo:[0,1] neg_hi:[0,1]
    v_pk_add_f32 v[18:19], v[18:19], v[26:27]
    v_pk_fma_f32 v[22:23], v[26:27], v[26:27], v[22:23]
    v_pk_add_f32 v[24:25], v[156:157], s[86:87] neg_lo:[0,1] neg_hi:[0,1]
    v_pk_add_f32 v[16:17], v[16:17], v[24:25]
    v_pk_fma_f32 v[20:21], v[24:25], v[24:25], v[20:21]
    v_pk_add_f32 v[26:27], v[158:159], s[86:87] neg_lo:[0,1] neg_hi:[0,1]
    v_pk_add_f32 v[18:19], v[18:19], v[26:27]
    v_pk_fma_f32 v[22:23], v[26:27], v[26:27], v[22:23]
    v_pk_add_f32 v[16:17], v[16:17], v[18:19]
    v_pk_add_f32 v[20:21], v[20:21], v[22:23]
    v_add_f32 v16, v16, v17
    v_add_f32 v20, v20, v21
    v_mov_b32 v18, 0x3a800000
    v_add_f32_dpp v16, v16, v16 row_shr:1 row_mask:0xf bank_mask:0xf bound_ctrl:0
    v_add_f32_dpp v20, v20, v20 row_shr:1 row_mask:0xf bank_mask:0xf bound_ctrl:0
    s_nop 0
    v_add_f32_dpp v16, v16, v16 row_shr:2 row_mask:0xf bank_mask:0xf bound_ctrl:0
    v_add_f32_dpp v20, v20, v20 row_shr:2 row_mask:0xf bank_mask:0xf bound_ctrl:0
    s_nop 0
    v_add_f32_dpp v16, v16, v16 row_shr:4 row_mask:0xf bank_mask:0xf bound_ctrl:0
    v_add_f32_dpp v20, v20, v20 row_shr:4 row_mask:0xf bank_mask:0xf bound_ctrl:0
    s_nop 0
    v_add_f32_dpp v16, v16, v16 row_shr:8 row_mask:0xf bank_mask:0xf bound_ctrl:0
    v_add_f32_dpp v20, v20, v20 row_shr:8 row_mask:0xf bank_mask:0xf bound_ctrl:0
    s_nop 0
    v_add_f32_dpp v16, v16, v16 row_bcast:15 row_mask:0xa bank_mask:0xf
    v_add_f32_dpp v20, v20, v20 row_bcast:15 row_mask:0xa bank_mask:0xf
    s_nop 0
    v_add_f32_dpp v16, v16, v16 row_bcast:31 row_mask:0xc bank_mask:0xf
    v_add_f32_dpp v20, v20, v20 row_bcast:31 row_mask:0xc bank_mask:0xf
    v_readlane_b32 s84, v16, 63
    v_readlane_b32 s85, v20, 63
    s_nop 0
    v_mul_f32 v16, s84, v18
    v_mul_f32 v20, s85, v18
    v_add_f32 v24, s86, v16
    v_fma_f32 v16, -v16, v16, v20
    v_max_f32 v16, 0, v16
    v_cvt_pk_bf16_f32 v16, v16, v16
    v_and_b32 v16, 0xffff0000, v16
    v_add_f32 v16, 0x3727c5ac, v16
    v_cvt_pk_bf16_f32 v16, v16, v16
    v_and_b32 v16, 0xffff0000, v16
    v_sqrt_f32 v16, v16
    v_cvt_pk_bf16_f32 v24, v24, v24
    v_and_b32 v24, 0xffff0000, v24
    v_cvt_pk_bf16_f32 v16, v16, v16
    v_and_b32 v16, 0xffff0000, v16
    v_rcp_f32 v16, v16
    v_mov_b32 v25, v24
    v_pk_add_f32 v[144:145], v[144:145], v[24:25] neg_lo:[0,1] neg_hi:[0,1]
    v_mov_b32 v17, v16
    v_cvt_pk_bf16_f32 v145, v144, v145
    v_lshlrev_b32 v144, 16, v145
    v_and_b32 v145, 0xffff0000, v145
    v_pk_mul_f32 v[144:145], v[144:145], v[16:17]
    v_cvt_pk_bf16_f32 v48, v144, v145
    v_pk_add_f32 v[146:147], v[146:147], v[24:25] neg_lo:[0,1] neg_hi:[0,1]
    v_cvt_pk_bf16_f32 v147, v146, v147
    v_lshlrev_b32 v146, 16, v147
    v_and_b32 v147, 0xffff0000, v147
    v_pk_mul_f32 v[146:147], v[146:147], v[16:17]
    v_cvt_pk_bf16_f32 v49, v146, v147
    v_pk_add_f32 v[148:149], v[148:149], v[24:25] neg_lo:[0,1] neg_hi:[0,1]
    v_cvt_pk_bf16_f32 v149, v148, v149
    v_lshlrev_b32 v148, 16, v149
    v_and_b32 v149, 0xffff0000, v149
    v_pk_mul_f32 v[148:149], v[148:149], v[16:17]
    v_cvt_pk_bf16_f32 v50, v148, v149
    v_pk_add_f32 v[150:151], v[150:151], v[24:25] neg_lo:[0,1] neg_hi:[0,1]
    v_cvt_pk_bf16_f32 v151, v150, v151
    v_lshlrev_b32 v150, 16, v151
    v_and_b32 v151, 0xffff0000, v151
    v_pk_mul_f32 v[150:151], v[150:151], v[16:17]
    v_cvt_pk_bf16_f32 v51, v150, v151
    v_pk_add_f32 v[152:153], v[152:153], v[24:25] neg_lo:[0,1] neg_hi:[0,1]
    v_cvt_pk_bf16_f32 v153, v152, v153
    v_lshlrev_b32 v152, 16, v153
    v_and_b32 v153, 0xffff0000, v153
    v_pk_mul_f32 v[152:153], v[152:153], v[16:17]
    v_cvt_pk_bf16_f32 v52, v152, v153
    v_pk_add_f32 v[154:155], v[154:155], v[24:25] neg_lo:[0,1] neg_hi:[0,1]
    v_cvt_pk_bf16_f32 v155, v154, v155
    v_lshlrev_b32 v154, 16, v155
    v_and_b32 v155, 0xffff0000, v155
    v_pk_mul_f32 v[154:155], v[154:155], v[16:17]
    v_cvt_pk_bf16_f32 v53, v154, v155
    v_pk_add_f32 v[156:157], v[156:157], v[24:25] neg_lo:[0,1] neg_hi:[0,1]
    v_cvt_pk_bf16_f32 v157, v156, v157
    v_lshlrev_b32 v156, 16, v157
    v_and_b32 v157, 0xffff0000, v157
    v_pk_mul_f32 v[156:157], v[156:157], v[16:17]
    v_cvt_pk_bf16_f32 v54, v156, v157
    v_pk_add_f32 v[158:159], v[158:159], v[24:25] neg_lo:[0,1] neg_hi:[0,1]
    v_cvt_pk_bf16_f32 v159, v158, v159
    v_lshlrev_b32 v158, 16, v159
    v_and_b32 v159, 0xffff0000, v159
    v_pk_mul_f32 v[158:159], v[158:159], v[16:17]
    v_cvt_pk_bf16_f32 v55, v158, v159
    ds_write_b128 v31, v[48:51]
    ds_write_b128 v31, v[52:55] offset:16
    s_add_u32 s68, s68, 1
    v_mov_b32 v9, s68
    v_mov_b32 v33, v9
    v_mov_b32 v35, v9
    s_lshl_b32 s89, s3, 6
    s_bfe_u32 s42, s2, 0x20004
    s_lshl_b32 s42, s42, 15
    s_lshr_b32 s85, s2, 6
    s_lshl_b32 s43, s85, 9
    s_lshl_b32 s85, s85, 13
    s_add_u32 s42, s42, s85
    s_and_b32 s85, s2, 15
    s_lshl_b32 s85, s85, 9
    s_add_u32 s42, s42, s85
    s_add_u32 s42, s42, s89
    s_add_u32 s42, s42, 1048576
    v_lshrrev_b32 v16, 2, v1
    v_and_b32 v17, 3, v0
    v_lshlrev_b32 v17, 4, v17
    v_lshl_add_u32 v40, v16, 17, v17
    v_lshl_add_u32 v41, v16, 13, v17
    v_add_u32 v28, s43, v7
    s_waitcnt vmcnt(0)
    s_lshl_b32 s87, s3, 12
    s_add_u32 m0, s87, 32768
    s_nop 0
    buffer_load_dwordx4 v112, s[12:15], s72 offen offset:0 nt lds
    buffer_load_dwordx4 v113, s[12:15], s72 offen offset:1024 nt lds
    buffer_load_dwordx4 v114, s[12:15], s72 offen offset:2048 nt lds
    buffer_load_dwordx4 v115, s[12:15], s72 offen offset:3072 nt lds
    s_lshl_b32 s87, s3, 12
    s_add_u32 m0, s87, 65536
    s_waitcnt lgkmcnt(0)
    s_barrier
    ds_read_b128 v[112:115], v28 offset:0
    ds_read_b64_tr_b16 v[48:49], v15 offset:0
    ds_read_b64_tr_b16 v[50:51], v15 offset:512
    ds_read_b128 v[116:119], v28 offset:128
    ds_read_b64_tr_b16 v[52:53], v15 offset:8192
    ds_read_b64_tr_b16 v[54:55], v15 offset:8704
    ds_read_b128 v[120:123], v28 offset:256
    ds_read_b64_tr_b16 v[56:57], v15 offset:16384
    ds_read_b64_tr_b16 v[58:59], v15 offset:16896
    ds_read_b128 v[124:127], v28 offset:384
    ds_read_b64_tr_b16 v[60:61], v15 offset:24576
    ds_read_b64_tr_b16 v[62:63], v15 offset:25088
    s_waitcnt lgkmcnt(9)
    v_mfma_f32_16x16x32_bf16 v[144:147], v[112:115], v[48:51], 0
    s_waitcnt lgkmcnt(6)
    v_mfma_f32_16x16x32_bf16 v[144:147], v[116:119], v[52:55], v[144:147]
    s_waitcnt lgkmcnt(3)
    v_mfma_f32_16x16x32_bf16 v[144:147], v[120:123], v[56:59], v[144:147]
    s_waitcnt lgkmcnt(0)
    v_mfma_f32_16x16x32_bf16 v[144:147], v[124:127], v[60:63], v[144:147]
    s_nop 7
    v_permlane32_swap_b32 v144, v18
    v_permlane32_swap_b32 v145, v19
    v_permlane32_swap_b32 v146, v20
    v_permlane32_swap_b32 v147, v21
    v_add_f32_dpp v144, v18, v144 row_shl:8 row_mask:0xf bank_mask:0xf bound_ctrl:0
    v_add_f32_dpp v145, v19, v145 row_shl:8 row_mask:0xf bank_mask:0xf bound_ctrl:0
    v_add_f32_dpp v146, v20, v146 row_shl:8 row_mask:0xf bank_mask:0xf bound_ctrl:0
    v_add_f32_dpp v147, v21, v147 row_shl:8 row_mask:0xf bank_mask:0xf bound_ctrl:0
    s_mov_b32 exec_lo, 0xff00ff
    s_mov_b32 exec_hi, 0x0
    ds_write_b32 v221, v144 offset:0
    ds_write_b32 v221, v145 offset:32
    ds_write_b32 v221, v146 offset:64
    ds_write_b32 v221, v147 offset:96
    s_mov_b64 exec, -1
    ds_read_b32 v32, v222
    ds_read_b32 v34, v222 offset:4
    s_waitcnt lgkmcnt(0)
    s_mov_b32 exec_lo, 0xffffffff
    s_mov_b32 exec_hi, 0x0
    buffer_store_dwordx4 v[32:35], v40, s[36:39], s42 offen sc1
    s_mov_b64 exec, -1
    s_barrier
    s_lshl_b32 s87, s3, 12
    s_add_u32 m0, s87, 65536
    s_nop 0
    buffer_load_dwordx4 v212, s[16:19], s72 offen offset:0 nt lds
    buffer_load_dwordx4 v213, s[16:19], s72 offen offset:1024 nt lds
    buffer_load_dwordx4 v212, s[16:19], s72 offen offset:2048 nt lds
    buffer_load_dwordx4 v213, s[16:19], s72 offen offset:3072 nt lds
    s_mov_b32 s32, s62
    s_mov_b32 s33, s63
    s_mov_b32 s34, 16384
    s_mov_b32 s35, 0x20000
    s_and_b32 s40, s71, 7
    s_lshl_b32 s40, s40, 11
    s_lshl_b32 s86, s4, 8
    s_add_u32 s40, s40, s86
    s_lshr_b32 s86, s71, 3
    s_lshl_b32 s86, s86, 7
    s_add_u32 s40, s40, s86
    v_and_b32 v20, 0x7c, v13
    buffer_load_dword v10, v20, s[8:11], s40 offen
    s_mov_b32 s28, s60
    s_mov_b32 s29, s61
    s_mov_b32 s30, 7340032
    s_mov_b32 s31, 0x20000
    s_bitcmp1_b32 s5, 0
    s_cbranch_scc1 L_setq
    s_mov_b32 s24, s52
    s_mov_b32 s25, s53
    s_mov_b32 s26, 8388608
    s_mov_b32 s27, 0x20000
    s_lshl_b32 s88, s3, 13
    s_lshl_b32 s74, s71, 19
    s_lshl_b32 s87, s4, 8
    s_add_u32 s74, s74, s87
    s_add_u32 s74, s74, s88
    s_lshl_b32 s86, s4, 1
    s_lshr_b32 s87, s71, 3
    s_add_u32 s86, s86, s87
    s_mul_i32 s75, s86, 458752
    s_and_b32 s87, s71, 7
    s_lshl_b32 s87, s87, 8
    s_add_u32 s75, s75, s87
    s_add_u32 s75, s75, s88
    s_and_b32 s86, s3, 2
    s_lshl_b32 s86, s86, 1
    v_or_b32 v20, s86, v5
    v_lshlrev_b32 v20, 1, v20
    v_xor_b32 v20, v4, v20
    v_lshlrev_b32 v20, 4, v20
    v_lshl_add_u32 v6, v5, 11, v20
    s_nop 0
    s_branch L_setdone
L_setq:
    s_add_u32 s88, s4, 3
    s_and_b32 s88, s88, 7
    s_cmp_ge_u32 s71, 7
    s_cselect_b32 s87, 1, 0
    s_cmp_eq_u32 s71, 14
    s_cselect_b32 s87, 0, s87
    s_cmp_eq_u32 s87, 1
    s_cselect_b32 s24, s58, s56
    s_cselect_b32 s25, s59, s57
    s_cselect_b32 s86, 7, 0
    s_sub_u32 s86, s71, s86
    s_cmp_lt_u32 s71, 14
    s_cselect_b32 s26, 7340032, 0
    s_mov_b32 s27, 0x20000
    s_cselect_b32 s86, s86, s88
    s_mul_i32 s74, s4, 7
    s_add_u32 s74, s74, s86
    s_lshl_b32 s74, s74, 7
    s_mov_b32 s75, s86
    s_mul_i32 s86, s3, 57344
    s_add_u32 s74, s74, s86
    s_movk_i32 s86, 7168
    s_and_b32 s87, s3, 3
    s_lshl_b32 s87, s87, 1
    v_and_b32 v19, 1, v5
    v_or_b32 v19, s87, v19
    v_xor_b32 v19, v2, v19
    v_lshlrev_b32 v19, 4, v19
    v_mad_u32_u24 v6, v3, s86, v19
L_setdone:
    v_bfe_u32 v22, v0, 2, 4
    v_and_b32 v23, 3, v0
    v_and_b32 v24, 7, v22
    v_xor_b32 v24, s3, v24
    v_lshlrev_b32 v24, 5, v24
    v_lshl_add_u32 v24, v22, 8, v24
    v_lshl_add_u32 v14, v23, 3, v24
    v_bfe_u32 v22, v0, 2, 2
    v_and_b32 v23, 1, v5
    v_lshl_or_b32 v23, v23, 2, v22
    v_xor_b32 v23, s3, v23
    v_lshlrev_b32 v23, 5, v23
    v_lshl_add_u32 v23, v22, 8, v23
    v_lshl_add_u32 v23, v5, 11, v23
    v_and_b32 v22, 3, v0
    v_lshl_add_u32 v216, v22, 3, v23
    s_movk_i32 s86, 1056
    v_mul_lo_u32 v217, v2, s86
    v_lshl_add_u32 v217, v5, 4, v217
    v_add_u32 v217, 131072, v217
    s_mul_i32 s84, s3, 1056
    s_add_u32 s84, s84, 131072
    v_add_u32 v218, s84, v12
    v_add_u32 v219, s84, v13
    s_lshl_b32 s89, s3, 6
    s_lshl_b32 s44, s70, 15
    s_add_u32 s44, s44, s73
    s_add_u32 s44, s44, 1048576
    s_add_u32 s45, s44, 8192
    s_add_u32 s46, s44, 16384
    s_add_u32 s47, s44, 24576
    s_lshl_b32 s91, s3, 7
    s_lshl_b32 s48, s70, 15
    s_lshl_b32 s86, s7, 10
    s_add_u32 s48, s48, s86
    s_add_u32 s48, s48, s91
    s_add_u32 s48, s48, 2097152
    s_xor_b32 s49, s48, 16777216
    s_lshl_b32 s50, s70, 10
    s_lshl_b32 s86, s7, 4
    s_add_u32 s50, s50, s86
    s_add_u32 s50, s50, 3145728
    s_xor_b32 s51, s50, 16777216
    v_lshlrev_b32 v16, 4, v2
    v_lshl_add_u32 v44, v3, 13, v16
    v_lshl_add_u32 v42, v3, 14, v16
    v_lshlrev_b32 v209, 7, v2
    v_lshlrev_b32 v210, 3, v4
    v_lshlrev_b32 v211, 4, v4
    s_lshl_b32 s41, s4, 8
    s_add_u32 s41, s41, 4096
    s_lshl_b32 s63, s71, 3
    s_add_u32 s63, s63, s41
    s_bitcmp1_b32 s5, 0
    s_cbranch_scc1 L_setq2
    s_lshl_b32 s52, s71, 13
    s_add_u32 s52, s52, s73
    s_add_u32 s52, s52, 3276800
    s_lshr_b32 s84, s3, 2
    s_lshl_b32 s84, s84, 13
    s_and_b32 s85, s3, 3
    s_lshl_b32 s85, s85, 7
    s_add_u32 s84, s84, s85
    s_lshl_b32 s53, s4, 17
    s_lshl_b32 s85, s71, 9
    s_add_u32 s53, s53, s85
    s_add_u32 s53, s53, s84
    s_add_u32 s53, s53, 4194304
    s_and_b32 s60, s71, 7
    s_lshl_b32 s60, s60, 17
    s_lshl_b32 s85, s4, 1
    s_lshr_b32 s86, s71, 3
    s_add_u32 s85, s85, s86
    s_lshl_b32 s85, s85, 9
    s_add_u32 s60, s60, s85
    s_add_u32 s60, s60, s84
    s_add_u32 s60, s60, 5242880
    s_lshl_b32 s55, s4, 17
    s_and_b32 s85, s71, 7
    s_lshl_b32 s85, s85, 14
    s_add_u32 s55, s55, s85
    s_lshl_b32 s85, s86, 13
    s_add_u32 s55, s55, s85
    s_add_u32 s61, s55, 5242880
    s_add_u32 s62, s61, 4096
    s_add_u32 s55, s55, 4194304
    s_add_u32 s56, s55, 4096
    s_lshl_b32 s57, s40, 1
    s_add_u32 s57, s57, 3211264
    s_lshl_b32 s58, s4, 16
    s_lshl_b32 s85, s3, 13
    s_add_u32 s58, s58, s85
    s_mul_i32 s85, s86, 1792
    s_add_u32 s58, s58, s85
    s_add_u32 s58, s58, 3670016
    s_add_u32 s59, s58, 4096
    s_branch L_setdone2
L_setq2:
    s_add_u32 s63, s63, 128
    s_cmp_ge_u32 s71, 14
    s_cbranch_scc1 L_sets2
    s_cmp_ge_u32 s71, 7
    s_cselect_b32 s84, 1, 0
    s_add_u32 s84, s84, s71
    s_lshl_b32 s53, s84, 9
    s_lshl_b32 s84, s4, 16
    s_add_u32 s53, s53, s84
    s_add_u32 s53, s53, s89
    s_add_u32 s53, s53, 3670016
    s_lshl_b32 s55, s3, 12
    s_add_u32 s55, s55, 3211264
    s_add_u32 s84, s4, 3
    s_and_b32 s84, s84, 7
    s_cmp_eq_u32 s84, s75
    s_cselect_b32 s58, 12, 16
    s_cselect_b32 s59, 7, 15
    s_branch L_setdone2
L_sets2:
    s_sub_u32 s84, s71, 14
    s_lshl_b32 s53, s84, 12
    s_lshl_b32 s84, s4, 16
    s_add_u32 s53, s53, s84
    s_add_u32 s53, s53, s89
    s_add_u32 s53, s53, 3673600
    s_mov_b32 s58, 16
    s_mov_b32 s59, 8
    s_sub_u32 s84, s71, 14
    s_lshl_b32 s84, s84, 3
    s_add_u32 s84, s84, s3
    s_lshl_b32 s57, s84, 13
    s_lshl_b32 s85, s4, 10
    s_add_u32 s57, s57, s85
    s_add_u32 s57, s57, 3276800
    s_lshl_b32 s85, s4, 4
    s_add_u32 s84, s84, s85
    s_lshl_b32 s56, s84, 8
    s_add_u32 s56, s56, 3145728
    s_lshl_b32 s52, s84, 13
    s_add_u32 s52, s52, 2097152
    s_add_u32 s55, s52, 4096
L_setdone2:
    s_xor_b32 s54, s53, 16777216
    s_mov_b32 s64, 0
    s_mov_b32 s65, 65536
    s_bitcmp1_b32 s5, 0
    s_cselect_b32 s65, 458752, s65
    s_mul_i32 s84, s3, 272
    s_add_u32 s84, s84, 147968
    v_add_u32 v196, s84, v13
    s_movk_i32 s84, 272
    v_mul_lo_u32 v16, v2, s84
    v_lshl_add_u32 v201, v5, 4, v16
    v_add_u32 v201, 147968, v201
    v_lshl_add_u32 v203, v5, 3, v16
    v_add_u32 v203, 150144, v203
    s_lshl_b32 s86, s3, 5
    v_add_u32 v204, s86, v203
    v_add_u32 v202, 65536, v14
    v_lshlrev_b32 v205, 6, v2
    v_add_u32 v205, 152320, v205
    s_lshl_b32 s86, s3, 2
    v_add_u32 v206, s86, v205
    s_mov_b32 s90, 0x3db504f3
    s_mov_b32 s91, 0x3db504f3
    s_mov_b32 s92, 0x3fb8aa3b
    s_waitcnt vmcnt(3)
    s_mov_b32 s69, 1048592
    buffer_load_dwordx4 v[160:163], v8, s[36:39], s44 offen sc1
    buffer_load_dwordx4 v[164:167], v8, s[36:39], s45 offen sc1
    buffer_load_dwordx4 v[168:171], v8, s[36:39], s46 offen sc1
    buffer_load_dwordx4 v[172:175], v8, s[36:39], s47 offen sc1
    s_barrier
    s_mov_b32 exec_lo, 0xffffffff
    s_mov_b32 exec_hi, 0x0
    buffer_load_dwordx4 v[80:83], v44, s[36:39], s48 offen sc1
    s_mov_b32 exec_lo, 0xff
    s_mov_b32 exec_hi, 0x0
    buffer_load_dwordx4 v[84:87], v209, s[36:39], s50 offen sc1
    s_mov_b64 exec, -1
    s_lshl_b32 s84, s64, 13
    s_add_u32 s84, s84, 98304
    s_and_b32 s84, s84, 0x1ffff
    s_add_u32 m0, s84, s73
    s_mul_i32 s84, s64, s65
    s_add_u32 s84, s84, s74
    buffer_load_dwordx4 v6, s[24:27], s84 offen nt lds
    s_add_u32 s64, s64, 1
    s_lshl_b32 s84, s64, 13
    s_add_u32 s84, s84, 98304
    s_and_b32 s84, s84, 0x1ffff
    s_add_u32 m0, s84, s73
    s_mul_i32 s84, s64, s65
    s_add_u32 s84, s84, s74
    buffer_load_dwordx4 v6, s[24:27], s84 offen nt lds
    s_add_u32 s64, s64, 1
    s_waitcnt vmcnt(4)
    v_min_u32 v16, v161, v163
    v_min3_u32 v16, v16, v165, v167
    v_min3_u32 v16, v16, v169, v171
    v_min3_u32 v16, v16, v173, v175
    v_max_u32 v17, v161, v163
    v_max3_u32 v17, v17, v165, v167
    v_max3_u32 v17, v17, v169, v171
    v_max3_u32 v17, v17, v173, v175
    v_cmp_eq_u32 vcc, s68, v16
    v_cmp_eq_u32 s[98:99], s68, v17
    s_and_b64 vcc, vcc, s[98:99]
    s_cmp_eq_u64 vcc, exec
    s_nop 1
    s_cbranch_scc1 Ldone_2
    s_sub_u32 s69, s69, 1
Lpoll_1:
    buffer_load_dwordx4 v[160:163], v8, s[36:39], s44 offen sc1
    buffer_load_dwordx4 v[164:167], v8, s[36:39], s45 offen sc1
    buffer_load_dwordx4 v[168:171], v8, s[36:39], s46 offen sc1
    buffer_load_dwordx4 v[172:175], v8, s[36:39], s47 offen sc1
    s_waitcnt vmcnt(0)
    v_min_u32 v16, v161, v163
    v_min3_u32 v16, v16, v165, v167
    v_min3_u32 v16, v16, v169, v171
    v_min3_u32 v16, v16, v173, v175
    v_max_u32 v17, v161, v163
    v_max3_u32 v17, v17, v165, v167
    v_max3_u32 v17, v17, v169, v171
    v_max3_u32 v17, v17, v173, v175
    v_cmp_eq_u32 vcc, s68, v16
    v_cmp_eq_u32 s[98:99], s68, v17
    s_and_b64 vcc, vcc, s[98:99]
    s_cmp_eq_u64 vcc, exec
    s_nop 1
    s_cbranch_scc1 Ldone_2
    s_sub_u32 s69, s69, 1
    s_cmp_lg_u32 s69, 0
    s_cbranch_scc1 Lpoll_1
Ldone_2:
    ds_read_b128 v[144:147], v197
    ds_read_b128 v[148:151], v198
    ds_read_b128 v[152:155], v199
    ds_read_b128 v[156:159], v200
    v_add_f32 v16, v160, v164
    v_add_f32 v17, v162, v166
    v_add_f32 v18, v168, v172
    v_add_f32 v19, v170, v174
    v_add_f32 v16, v16, v18
    v_add_f32 v17, v17, v19
    v_cvt_pk_bf16_f32 v16, v16, v17
    ds_write_b32 v196, v16
    s_waitcnt lgkmcnt(0)
    s_barrier
    s_getreg_b32 s84, hwreg(HW_REG_IB_STS, 0, 4)
    s_cmp_gt_u32 s84, 0
    s_cbranch_scc1 Lpump_3
    s_lshl_b32 s84, s64, 13
    s_add_u32 s84, s84, 98304
    s_and_b32 s84, s84, 0x1ffff
    s_add_u32 m0, s84, s73
    s_mul_i32 s84, s64, s65
    s_add_u32 s84, s84, s74
    buffer_load_dwordx4 v6, s[24:27], s84 offen nt lds
    s_add_u32 s64, s64, 1
    s_lshl_b32 s84, s64, 13
    s_add_u32 s84, s84, 98304
    s_and_b32 s84, s84, 0x1ffff
    s_add_u32 m0, s84, s73
    s_mul_i32 s84, s64, s65
    s_add_u32 s84, s84, s74
    buffer_load_dwordx4 v6, s[24:27], s84 offen nt lds
    s_add_u32 s64, s64, 1
Lpump_3:
    ds_read_b128 v[112:115], v201 offset:0
    ds_read_b128 v[116:119], v201 offset:64
    ds_read_b128 v[120:123], v201 offset:128
    ds_read_b128 v[124:127], v201 offset:192
    ds_read_b64_tr_b16 v[48:49], v202 offset:0
    ds_read_b64_tr_b16 v[50:51], v202 offset:4096
    ds_read_b64_tr_b16 v[52:53], v202 offset:8192
    ds_read_b64_tr_b16 v[54:55], v202 offset:12288
    ds_read_b64_tr_b16 v[56:57], v202 offset:16384
    ds_read_b64_tr_b16 v[58:59], v202 offset:20480
    ds_read_b64_tr_b16 v[60:61], v202 offset:24576
    ds_read_b64_tr_b16 v[62:63], v202 offset:28672
    s_waitcnt lgkmcnt(11)
    v_mfma_f32_16x16x32_bf16 v[24:27], v[144:147], v[112:115], 0
    s_waitcnt lgkmcnt(10)
    v_mfma_f32_16x16x32_bf16 v[24:27], v[148:151], v[116:119], v[24:27]
    s_waitcnt lgkmcnt(9)
    v_mfma_f32_16x16x32_bf16 v[24:27], v[152:155], v[120:123], v[24:27]
    s_waitcnt lgkmcnt(8)
    v_mfma_f32_16x16x32_bf16 v[24:27], v[156:159], v[124:127], v[24:27]
    s_nop 7
    v_cvt_pk_bf16_f32 v16, v24, v25
    v_cvt_pk_bf16_f32 v17, v26, v27
    v_lshlrev_b32 v24, 16, v16
    v_and_b32 v25, 0xffff0000, v16
    v_lshlrev_b32 v26, 16, v17
    v_and_b32 v27, 0xffff0000, v17
    v_pk_mul_f32 v[24:25], v[24:25], s[90:91]
    v_pk_mul_f32 v[26:27], v[26:27], s[90:91]
    v_cvt_pk_bf16_f32 v16, v24, v25
    v_cvt_pk_bf16_f32 v17, v26, v27
    v_lshlrev_b32 v24, 16, v16
    v_and_b32 v25, 0xffff0000, v16
    v_lshlrev_b32 v26, 16, v17
    v_and_b32 v27, 0xffff0000, v17
    v_max3_f32 v18, v24, v25, v26
    v_max_f32 v18, v18, v27
    v_mov_b32 v20, v18
    s_nop 1
    v_permlane16_swap_b32 v18, v20
    v_max_f32 v18, v18, v20
    v_mov_b32 v20, v18
    s_nop 1
    v_permlane32_swap_b32 v18, v20
    v_max_f32 v18, v18, v20
    s_mov_b32 exec_lo, 0xff
    s_mov_b32 exec_hi, 0x0
    ds_write_b32 v206, v18
    s_mov_b64 exec, -1
    s_waitcnt lgkmcnt(0)
    s_barrier
    s_getreg_b32 s84, hwreg(HW_REG_IB_STS, 0, 4)
    s_cmp_gt_u32 s84, 0
    s_cbranch_scc1 Lpump_4
    s_lshl_b32 s84, s64, 13
    s_add_u32 s84, s84, 98304
    s_and_b32 s84, s84, 0x1ffff
    s_add_u32 m0, s84, s73
    s_mul_i32 s84, s64, s65
    s_add_u32 s84, s84, s74
    buffer_load_dwordx4 v6, s[24:27], s84 offen nt lds
    s_add_u32 s64, s64, 1
    s_lshl_b32 s84, s64, 13
    s_add_u32 s84, s84, 98304
    s_and_b32 s84, s84, 0x1ffff
    s_add_u32 m0, s84, s73
    s_mul_i32 s84, s64, s65
    s_add_u32 s84, s84, s74
    buffer_load_dwordx4 v6, s[24:27], s84 offen nt lds
    s_add_u32 s64, s64, 1
Lpump_4:
    ds_read_b128 v[160:163], v205
    ds_read_b128 v[164:167], v205 offset:16
    s_waitcnt lgkmcnt(0)
    v_max3_f32 v18, v160, v161, v162
    v_max3_f32 v20, v163, v164, v165
    v_max3_f32 v18, v18, v166, v167
    v_max_f32 v18, v18, v20
    v_sub_f32 v24, v24, v18
    v_sub_f32 v25, v25, v18
    v_sub_f32 v26, v26, v18
    v_sub_f32 v27, v27, v18
    v_mul_f32 v24, s92, v24
    v_mul_f32 v25, s92, v25
    v_mul_f32 v26, s92, v26
    v_mul_f32 v27, s92, v27
    v_exp_f32 v24, v24
    v_exp_f32 v25, v25
    v_exp_f32 v26, v26
    v_exp_f32 v27, v27
    v_mov_b32 v212, v18
    v_cvt_pk_bf16_f32 v16, v24, v25
    v_cvt_pk_bf16_f32 v17, v26, v27
    v_add_f32 v19, v24, v25
    v_add_f32 v20, v26, v27
    s_mov_b32 exec_lo, 0xff00ff
    s_mov_b32 exec_hi, 0xff00ff
    ds_write_b64 v204, v[16:17]
    s_mov_b64 exec, -1
    v_add_f32 v19, v19, v20
    v_mov_b32 v20, v19
    s_nop 1
    v_permlane16_swap_b32 v19, v20
    v_add_f32 v19, v19, v20
    v_mov_b32 v20, v19
    s_nop 1
    v_permlane32_swap_b32 v19, v20
    v_add_f32 v19, v19, v20
    s_mov_b32 exec_lo, 0xff
    s_mov_b32 exec_hi, 0x0
    ds_write_b32 v206, v19 offset:32
    s_mov_b64 exec, -1
    s_waitcnt lgkmcnt(0)
    s_barrier
    ds_read2_b64 v[112:115], v203 offset0:0 offset1:4
    ds_read2_b64 v[116:119], v203 offset0:8 offset1:12
    ds_read2_b64 v[120:123], v203 offset0:16 offset1:20
    ds_read2_b64 v[124:127], v203 offset0:24 offset1:28
    ds_read_b128 v[160:163], v205 offset:32
    ds_read_b128 v[164:167], v205 offset:48
    s_waitcnt lgkmcnt(5)
    v_mfma_f32_16x16x32_bf16 v[144:147], v[112:115], v[48:51], 0
    s_waitcnt lgkmcnt(4)
    v_mfma_f32_16x16x32_bf16 v[144:147], v[116:119], v[52:55], v[144:147]
    s_waitcnt lgkmcnt(3)
    v_mfma_f32_16x16x32_bf16 v[144:147], v[120:123], v[56:59], v[144:147]
    s_waitcnt lgkmcnt(2)
    v_mfma_f32_16x16x32_bf16 v[144:147], v[124:127], v[60:63], v[144:147]
    s_waitcnt lgkmcnt(0)
    v_add_f32 v19, v160, v161
    v_add_f32 v20, v162, v163
    v_add_f32 v21, v164, v165
    v_add_f32 v22, v166, v167
    v_add_f32 v19, v19, v20
    v_add_f32 v21, v21, v22
    v_add_f32 v214, v19, v21
    v_mov_b32 v213, v9
    v_mov_b32 v215, v9
    v_cvt_pk_bf16_f32 v16, v144, v145
    v_cvt_pk_bf16_f32 v17, v146, v147
    s_mov_b32 exec_lo, 0xffffffff
    s_mov_b32 exec_hi, 0x0
    ds_write_b32 v45, v16
    ds_write_b32 v45, v17 offset:64
    s_mov_b64 exec, -1
    ds_read_b32 v32, v222
    ds_read_b32 v34, v222 offset:4
    s_waitcnt lgkmcnt(0)
    s_mov_b32 exec_lo, 0xffffffff
    s_mov_b32 exec_hi, 0x0
    buffer_store_dwordx4 v[32:35], v44, s[36:39], s48 offen
    s_mov_b64 exec, -1
    s_barrier
    s_cmp_eq_u32 s3, 0
    s_cbranch_scc0 Lml_5
    s_mov_b32 exec_lo, 0xff
    s_mov_b32 exec_hi, 0x0
    buffer_store_dwordx4 v[212:215], v209, s[36:39], s50 offen
    s_mov_b64 exec, -1
Lml_5:
    s_bitcmp1_b32 s5, 0
    s_cbranch_scc1 L_roleq
Lrest_6:
    s_cmp_ge_u32 s64, 8
    s_cbranch_scc1 Lrestd_7
    s_lshl_b32 s84, s64, 13
    s_add_u32 s84, s84, 98304
    s_and_b32 s84, s84, 0x1ffff
    s_add_u32 m0, s84, s73
    s_mul_i32 s84, s64, s65
    s_add_u32 s84, s84, s74
    buffer_load_dwordx4 v6, s[24:27], s84 offen nt lds
    s_add_u32 s64, s64, 1
    s_branch Lrest_6
Lrestd_7:
    s_mov_b32 exec_lo, 0xffffffff
    s_mov_b32 exec_hi, 0x0
    buffer_store_dwordx4 v[32:35], v44, s[36:39], s49 offen sc1
    s_mov_b64 exec, -1
    s_cmp_eq_u32 s3, 0
    s_cbranch_scc0 Lml_8
    s_mov_b32 exec_lo, 0xff
    s_mov_b32 exec_hi, 0x0
    buffer_store_dwordx4 v[212:215], v209, s[36:39], s51 offen sc1
    s_mov_b64 exec, -1
Lml_8:
    buffer_load_dwordx4 v[176:179], v42, s[36:39], s53 offen sc1
    buffer_load_dwordx4 v[192:195], v211, s[36:39], s41 offen sc1
    s_waitcnt vmcnt(3)
    s_barrier
    v_add_u32 v30, 98304, v216
    ds_read_b64_tr_b16 v[48:49], v30 offset:0
    ds_read_b64_tr_b16 v[50:51], v30 offset:1024
    ds_read_b64_tr_b16 v[52:53], v30 offset:8192
    ds_read_b64_tr_b16 v[54:55], v30 offset:9216
    ds_read_b64_tr_b16 v[56:57], v30 offset:16384
    ds_read_b64_tr_b16 v[58:59], v30 offset:17408
    ds_read_b64_tr_b16 v[60:61], v30 offset:24576
    ds_read_b64_tr_b16 v[62:63], v30 offset:25600
    s_waitcnt lgkmcnt(4)
    v_add_u32 v30, 0, v216
    ds_read_b64_tr_b16 v[64:65], v30 offset:0
    ds_read_b64_tr_b16 v[66:67], v30 offset:1024
    ds_read_b64_tr_b16 v[68:69], v30 offset:8192
    ds_read_b64_tr_b16 v[70:71], v30 offset:9216
    ds_read_b64_tr_b16 v[72:73], v30 offset:16384
    ds_read_b64_tr_b16 v[74:75], v30 offset:17408
    ds_read_b64_tr_b16 v[76:77], v30 offset:24576
    ds_read_b64_tr_b16 v[78:79], v30 offset:25600
    s_mov_b32 s69, 1048592
    buffer_load_dwordx4 v[160:163], v8, s[36:39], s52 offen sc1
    s_waitcnt vmcnt(0)
    v_min_u32 v16, v161, v163
    v_max_u32 v17, v161, v163
    v_cmp_eq_u32 vcc, s68, v16
    v_cmp_eq_u32 s[98:99], s68, v17
    s_and_b64 vcc, vcc, s[98:99]
    s_cmp_eq_u64 vcc, exec
    s_nop 1
    s_cbranch_scc1 Ldone_10
    s_sub_u32 s69, s69, 1
Lpoll_9:
    buffer_load_dwordx4 v[160:163], v8, s[36:39], s52 offen sc1
    s_waitcnt vmcnt(0)
    v_min_u32 v16, v161, v163
    v_max_u32 v17, v161, v163
    v_cmp_eq_u32 vcc, s68, v16
    v_cmp_eq_u32 s[98:99], s68, v17
    s_and_b64 vcc, vcc, s[98:99]
    s_cmp_eq_u64 vcc, exec
    s_nop 1
    s_cbranch_scc1 Ldone_10
    s_sub_u32 s69, s69, 1
    s_cmp_lg_u32 s69, 0
    s_cbranch_scc1 Lpoll_9
Ldone_10:
    v_mov_b32 v161, v162
    ds_write_b64 v218, v[160:161]
    s_waitcnt lgkmcnt(0)
    s_barrier
    ds_read_b128 v[112:115], v217 offset:0
    ds_read_b128 v[116:119], v217 offset:64
    ds_read_b128 v[120:123], v217 offset:128
    ds_read_b128 v[124:127], v217 offset:192
    ds_read_b128 v[128:131], v217 offset:256
    ds_read_b128 v[132:135], v217 offset:320
    ds_read_b128 v[136:139], v217 offset:384
    ds_read_b128 v[140:143], v217 offset:448
    s_waitcnt lgkmcnt(7)
    v_mfma_f32_16x16x32_bf16 v[144:147], v[112:115], v[48:51], 0
    s_waitcnt lgkmcnt(6)
    v_mfma_f32_16x16x32_bf16 v[144:147], v[116:119], v[52:55], v[144:147]
    s_waitcnt lgkmcnt(5)
    v_mfma_f32_16x16x32_bf16 v[144:147], v[120:123], v[56:59], v[144:147]
    s_waitcnt lgkmcnt(4)
    v_mfma_f32_16x16x32_bf16 v[144:147], v[124:127], v[60:63], v[144:147]
    s_waitcnt lgkmcnt(3)
    v_mfma_f32_16x16x32_bf16 v[144:147], v[128:131], v[64:67], v[144:147]
    s_waitcnt lgkmcnt(2)
    v_mfma_f32_16x16x32_bf16 v[144:147], v[132:135], v[68:71], v[144:147]
    s_waitcnt lgkmcnt(1)
    v_mfma_f32_16x16x32_bf16 v[144:147], v[136:139], v[72:75], v[144:147]
    s_waitcnt lgkmcnt(0)
    v_mfma_f32_16x16x32_bf16 v[144:147], v[140:143], v[76:79], v[144:147]
    s_mov_b32 exec_lo, 0xffffffff
    s_mov_b32 exec_hi, 0x0
    s_nop 5
    ds_write_b32 v220, v144 offset:0
    ds_write_b32 v220, v145 offset:64
    ds_write_b32 v220, v146 offset:128
    ds_write_b32 v220, v147 offset:192
    s_mov_b64 exec, -1
    ds_read_b32 v32, v222
    ds_read_b32 v34, v222 offset:4
    s_waitcnt lgkmcnt(0)
    buffer_store_dwordx4 v[32:35], v42, s[36:39], s53 offen
    s_barrier
    s_cmp_lg_u32 s3, 1
    s_cbranch_scc1 Lfl_11
    v_mov_b32 v18, v9
    v_mov_b32 v19, v9
    s_mov_b32 exec_lo, 0x1
    s_mov_b32 exec_hi, 0x0
    buffer_store_dwordx2 v[18:19], v12, s[36:39], s63 offen
    s_mov_b64 exec, -1
Lfl_11:
    s_cmp_eq_u32 s3, 0
    s_cbranch_scc1 L_c1
    s_barrier
    buffer_store_dwordx4 v[32:35], v42, s[36:39], s54 offen sc1
    s_nop 0
    s_branch L_c1done
L_c1:
    v_and_b32 v11, 0xffff0000, v10
    v_lshlrev_b32 v10, 16, v10
    s_mov_b32 s69, 40
Lcan_12:
    buffer_load_dwordx2 v[18:19], v210, s[36:39], s41 offen sc1
    s_waitcnt vmcnt(0)
    v_cmp_eq_u32 vcc, s68, v18
    s_cmp_eq_u64 vcc, exec
    s_nop 2
    s_cbranch_scc1 Lcand_13
    s_sub_u32 s69, s69, 1
    s_cmp_lg_u32 s69, 0
    s_cbranch_scc1 Lcan_12
Lcand_13:
    s_mov_b32 s69, 1048592
    s_mov_b32 s66, 0
    buffer_load_dwordx4 v[160:163], v8, s[36:39], s55 offen offset:0 sc1
    buffer_load_dwordx4 v[164:167], v8, s[36:39], s55 offen offset:1024 sc1
    buffer_load_dwordx4 v[168:171], v8, s[36:39], s55 offen offset:2048 sc1
    buffer_load_dwordx4 v[172:175], v8, s[36:39], s55 offen offset:3072 sc1
    buffer_load_dwordx4 v[176:179], v8, s[36:39], s56 offen offset:0 sc1
    buffer_load_dwordx4 v[180:183], v8, s[36:39], s56 offen offset:1024 sc1
    buffer_load_dwordx4 v[184:187], v8, s[36:39], s56 offen offset:2048 sc1
    buffer_load_dwordx4 v[188:191], v8, s[36:39], s56 offen offset:3072 sc1
    s_barrier
    s_waitcnt vmcnt(0)
    v_min_u32 v16, v161, v163
    v_min3_u32 v16, v16, v165, v167
    v_min3_u32 v16, v16, v169, v171
    v_min3_u32 v16, v16, v173, v175
    v_min3_u32 v16, v16, v177, v179
    v_min3_u32 v16, v16, v181, v183
    v_min3_u32 v16, v16, v185, v187
    v_min3_u32 v16, v16, v189, v191
    v_max_u32 v17, v161, v163
    v_max3_u32 v17, v17, v165, v167
    v_max3_u32 v17, v17, v169, v171
    v_max3_u32 v17, v17, v173, v175
    v_max3_u32 v17, v17, v177, v179
    v_max3_u32 v17, v17, v181, v183
    v_max3_u32 v17, v17, v185, v187
    v_max3_u32 v17, v17, v189, v191
    v_cmp_eq_u32 vcc, s68, v16
    v_cmp_eq_u32 s[98:99], s68, v17
    s_and_b64 vcc, vcc, s[98:99]
    s_cmp_eq_u64 vcc, exec
    s_nop 1
    s_cbranch_scc1 Ldone_15
    buffer_store_dwordx4 v[32:35], v42, s[36:39], s54 offen sc1
    s_mov_b32 s66, 1
    s_sub_u32 s69, s69, 1
Lpoll_14:
    s_and_b32 s94, s69, 15
    s_cmp_eq_u32 s94, 0
    s_cbranch_scc1 Lglob_16
    buffer_load_dwordx4 v[160:163], v8, s[36:39], s55 offen offset:0 sc1
    buffer_load_dwordx4 v[164:167], v8, s[36:39], s55 offen offset:1024 sc1
    buffer_load_dwordx4 v[168:171], v8, s[36:39], s55 offen offset:2048 sc1
    buffer_load_dwordx4 v[172:175], v8, s[36:39], s55 offen offset:3072 sc1
    buffer_load_dwordx4 v[176:179], v8, s[36:39], s56 offen offset:0 sc1
    buffer_load_dwordx4 v[180:183], v8, s[36:39], s56 offen offset:1024 sc1
    buffer_load_dwordx4 v[184:187], v8, s[36:39], s56 offen offset:2048 sc1
    buffer_load_dwordx4 v[188:191], v8, s[36:39], s56 offen offset:3072 sc1
    s_branch Ljoin_17
Lglob_16:
    s_xor_b32 s55, s55, 16777216
    s_xor_b32 s56, s56, 16777216
    buffer_load_dwordx4 v[160:163], v8, s[36:39], s55 offen offset:0 sc1
    buffer_load_dwordx4 v[164:167], v8, s[36:39], s55 offen offset:1024 sc1
    buffer_load_dwordx4 v[168:171], v8, s[36:39], s55 offen offset:2048 sc1
    buffer_load_dwordx4 v[172:175], v8, s[36:39], s55 offen offset:3072 sc1
    buffer_load_dwordx4 v[176:179], v8, s[36:39], s56 offen offset:0 sc1
    buffer_load_dwordx4 v[180:183], v8, s[36:39], s56 offen offset:1024 sc1
    buffer_load_dwordx4 v[184:187], v8, s[36:39], s56 offen offset:2048 sc1
    buffer_load_dwordx4 v[188:191], v8, s[36:39], s56 offen offset:3072 sc1
    s_xor_b32 s55, s55, 16777216
    s_xor_b32 s56, s56, 16777216
Ljoin_17:
    s_waitcnt vmcnt(0)
    v_min_u32 v16, v161, v163
    v_min3_u32 v16, v16, v165, v167
    v_min3_u32 v16, v16, v169, v171
    v_min3_u32 v16, v16, v173, v175
    v_min3_u32 v16, v16, v177, v179
    v_min3_u32 v16, v16, v181, v183
    v_min3_u32 v16, v16, v185, v187
    v_min3_u32 v16, v16, v189, v191
    v_max_u32 v17, v161, v163
    v_max3_u32 v17, v17, v165, v167
    v_max3_u32 v17, v17, v169, v171
    v_max3_u32 v17, v17, v173, v175
    v_max3_u32 v17, v17, v177, v179
    v_max3_u32 v17, v17, v181, v183
    v_max3_u32 v17, v17, v185, v187
    v_max3_u32 v17, v17, v189, v191
    v_cmp_eq_u32 vcc, s68, v16
    v_cmp_eq_u32 s[98:99], s68, v17
    s_and_b64 vcc, vcc, s[98:99]
    s_cmp_eq_u64 vcc, exec
    s_nop 1
    s_cbranch_scc1 Ldone_15
    s_sub_u32 s69, s69, 1
    s_cmp_lg_u32 s69, 0
    s_cbranch_scc1 Lpoll_14
Ldone_15:
    v_add_f32 v18, v160, v164
    v_add_f32 v20, v168, v172
    v_add_f32 v22, v176, v180
    v_add_f32 v24, v184, v188
    v_add_f32 v19, v162, v166
    v_add_f32 v21, v170, v174
    v_add_f32 v23, v178, v182
    v_add_f32 v25, v186, v190
    v_add_f32 v18, v18, v20
    v_add_f32 v22, v22, v24
    v_add_f32 v19, v19, v21
    v_add_f32 v23, v23, v25
    v_add_f32 v18, v18, v22
    v_add_f32 v19, v19, v23
    s_nop 0
    v_permlane32_swap_b32 v18, v20
    v_permlane32_swap_b32 v19, v21
    v_add_f32 v18, v18, v20
    v_add_f32 v19, v19, v21
    v_cvt_pk_bf16_f32 v16, v18, v19
    v_lshlrev_b32 v18, 16, v16
    v_and_b32 v19, 0xffff0000, v16
    v_add_f32 v18, v18, v10
    v_add_f32 v19, v19, v11
    v_cvt_pk_bf16_f32 v16, v18, v19
    v_mov_b32 v17, v9
    s_mov_b32 exec_lo, 0xffffffff
    s_mov_b32 exec_hi, 0x0
    buffer_store_dwordx2 v[16:17], v12, s[36:39], s57 offen sc1
    s_mov_b64 exec, -1
    v_lshlrev_b32 v10, 16, v16
    v_and_b32 v11, 0xffff0000, v16
    s_cmp_eq_u32 s66, 1
    s_cbranch_scc1 Ldef_18
    buffer_store_dwordx4 v[32:35], v42, s[36:39], s54 offen sc1
Ldef_18:
    buffer_load_dwordx4 v[160:163], v8, s[36:39], s61 offen offset:0 sc1
    buffer_load_dwordx4 v[164:167], v8, s[36:39], s61 offen offset:1024 sc1
    buffer_load_dwordx4 v[168:171], v8, s[36:39], s61 offen offset:2048 sc1
    buffer_load_dwordx4 v[172:175], v8, s[36:39], s61 offen offset:3072 sc1
    buffer_load_dwordx4 v[176:179], v8, s[36:39], s62 offen offset:0 sc1
    buffer_load_dwordx4 v[180:183], v8, s[36:39], s62 offen offset:1024 sc1
    buffer_load_dwordx4 v[184:187], v8, s[36:39], s62 offen offset:2048 sc1
    buffer_load_dwordx4 v[188:191], v8, s[36:39], s62 offen offset:3072 sc1
L_c1done:
    s_barrier
    s_add_u32 m0, s73, 32768
    s_add_u32 s84, s75, 0
    buffer_load_dwordx4 v6, s[28:31], s84 offen nt lds
    s_add_u32 m0, s73, 40960
    s_add_u32 s84, s75, 65536
    buffer_load_dwordx4 v6, s[28:31], s84 offen nt lds
    s_add_u32 m0, s73, 49152
    s_add_u32 s84, s75, 131072
    buffer_load_dwordx4 v6, s[28:31], s84 offen nt lds
    s_add_u32 m0, s73, 57344
    s_add_u32 s84, s75, 196608
    buffer_load_dwordx4 v6, s[28:31], s84 offen nt lds
    s_add_u32 m0, s73, 65536
    s_add_u32 s84, s75, 262144
    buffer_load_dwordx4 v6, s[28:31], s84 offen nt lds
    s_add_u32 m0, s73, 73728
    s_add_u32 s84, s75, 327680
    buffer_load_dwordx4 v6, s[28:31], s84 offen nt lds
    s_add_u32 m0, s73, 81920
    s_add_u32 s84, s75, 393216
    buffer_load_dwordx4 v6, s[28:31], s84 offen nt lds
    s_mov_b32 s90, 0xbfb8aa3b
    s_mov_b32 s91, 0xbfb8aa3b
    s_mov_b32 s92, 1.0
    s_mov_b32 s93, 1.0
    s_add_u32 s41, s41, 128
    s_add_u32 s84, s4, 3
    s_and_b32 s84, s84, 7
    s_lshl_b32 s84, s84, 9
    s_lshr_b32 s85, s71, 3
    s_mul_i32 s85, s85, 1792
    s_sub_u32 s85, s85, s84
    v_add_u32 v44, s85, v8
    v_add_u32 v46, 1024, v44
    s_movk_i32 s85, 512
    v_cmp_gt_u32 s[76:77], s85, v44
    v_cmp_gt_u32 s[78:79], s85, v46
    s_and_b32 s79, s79, 0xffff
    s_sub_u32 s84, 3584, s84
    v_add_u32 v44, s84, v8
    s_waitcnt vmcnt(0)
    v_mov_b32 v164, 0
    v_mov_b32 v165, v9
    v_mov_b32 v166, 0
    v_mov_b32 v167, v9
    v_mov_b32 v168, 0
    v_mov_b32 v169, v9
    v_mov_b32 v170, 0
    v_mov_b32 v171, v9
    v_mov_b32 v172, 0
    v_mov_b32 v173, v9
    v_mov_b32 v174, 0
    v_mov_b32 v175, v9
    v_mov_b32 v180, 0
    v_mov_b32 v181, v9
    v_mov_b32 v182, 0
    v_mov_b32 v183, v9
    v_mov_b32 v184, 0
    v_mov_b32 v185, v9
    v_mov_b32 v186, 0
    v_mov_b32 v187, v9
    v_mov_b32 v188, 0
    v_mov_b32 v189, v9
    v_mov_b32 v190, 0
    v_mov_b32 v191, v9
    s_barrier
    v_add_u32 v30, 32768, v216
    ds_read_b64_tr_b16 v[48:49], v30 offset:0
    ds_read_b64_tr_b16 v[50:51], v30 offset:1024
    ds_read_b64_tr_b16 v[52:53], v30 offset:8192
    ds_read_b64_tr_b16 v[54:55], v30 offset:9216
    ds_read_b64_tr_b16 v[56:57], v30 offset:16384
    ds_read_b64_tr_b16 v[58:59], v30 offset:17408
    ds_read_b64_tr_b16 v[60:61], v30 offset:24576
    ds_read_b64_tr_b16 v[62:63], v30 offset:25600
    s_waitcnt lgkmcnt(4)
    v_add_u32 v30, 65536, v216
    ds_read_b64_tr_b16 v[64:65], v30 offset:0
    ds_read_b64_tr_b16 v[66:67], v30 offset:1024
    ds_read_b64_tr_b16 v[68:69], v30 offset:8192
    ds_read_b64_tr_b16 v[70:71], v30 offset:9216
    ds_read_b64_tr_b16 v[72:73], v30 offset:16384
    ds_read_b64_tr_b16 v[74:75], v30 offset:17408
    s_mov_b32 s69, 160
Lcan_19:
    buffer_load_dwordx2 v[18:19], v210, s[36:39], s41 offen sc1
    s_waitcnt vmcnt(0)
    v_cmp_eq_u32 vcc, s68, v18
    s_cmp_eq_u64 vcc, exec
    s_nop 2
    s_cbranch_scc1 Lcand_20
    s_sub_u32 s69, s69, 1
    s_cmp_lg_u32 s69, 0
    s_cbranch_scc1 Lcan_19
Lcand_20:
    s_mov_b32 s69, 1048592
    buffer_load_dwordx4 v[160:163], v8, s[36:39], s58 offen sc1
    buffer_load_dwordx4 v[176:179], v8, s[36:39], s59 offen sc1
    s_mov_b32 exec_lo, 0xffffffff
    s_mov_b32 exec_hi, 0xffff
    buffer_load_dwordx4 v[164:167], v8, s[36:39], s58 offen offset:1024 sc1
    buffer_load_dwordx4 v[180:183], v8, s[36:39], s59 offen offset:1024 sc1
    s_mov_b64 exec, s[76:77]
    s_cbranch_execz Lcs_23
    buffer_load_dwordx4 v[168:171], v44, s[36:39], s58 offen offset:0 sc1
    buffer_load_dwordx4 v[184:187], v44, s[36:39], s59 offen offset:0 sc1
Lcs_23:
    s_mov_b64 exec, s[78:79]
    s_cbranch_execz Lcs_24
    buffer_load_dwordx4 v[172:175], v44, s[36:39], s58 offen offset:1024 sc1
    buffer_load_dwordx4 v[188:191], v44, s[36:39], s59 offen offset:1024 sc1
Lcs_24:
    s_mov_b64 exec, -1
    s_waitcnt vmcnt(0)
    v_min_u32 v16, v161, v163
    v_min3_u32 v16, v16, v165, v167
    v_min3_u32 v16, v16, v169, v171
    v_min3_u32 v16, v16, v173, v175
    v_min3_u32 v16, v16, v177, v179
    v_min3_u32 v16, v16, v181, v183
    v_min3_u32 v16, v16, v185, v187
    v_min3_u32 v16, v16, v189, v191
    v_max_u32 v17, v161, v163
    v_max3_u32 v17, v17, v165, v167
    v_max3_u32 v17, v17, v169, v171
    v_max3_u32 v17, v17, v173, v175
    v_max3_u32 v17, v17, v177, v179
    v_max3_u32 v17, v17, v181, v183
    v_max3_u32 v17, v17, v185, v187
    v_max3_u32 v17, v17, v189, v191
    v_cmp_eq_u32 vcc, s68, v16
    v_cmp_eq_u32 s[98:99], s68, v17
    s_and_b64 vcc, vcc, s[98:99]
    s_cmp_eq_u64 vcc, exec
    s_nop 1
    s_cbranch_scc1 Ldone_22
    s_sub_u32 s69, s69, 1
Lpoll_21:
    s_and_b32 s94, s69, 15
    s_cmp_eq_u32 s94, 0
    s_cbranch_scc1 Lglob_25
    buffer_load_dwordx4 v[160:163], v8, s[36:39], s58 offen sc1
    buffer_load_dwordx4 v[176:179], v8, s[36:39], s59 offen sc1
    s_mov_b32 exec_lo, 0xffffffff
    s_mov_b32 exec_hi, 0xffff
    buffer_load_dwordx4 v[164:167], v8, s[36:39], s58 offen offset:1024 sc1
    buffer_load_dwordx4 v[180:183], v8, s[36:39], s59 offen offset:1024 sc1
    s_mov_b64 exec, s[76:77]
    s_cbranch_execz Lcs_27
    buffer_load_dwordx4 v[168:171], v44, s[36:39], s58 offen offset:0 sc1
    buffer_load_dwordx4 v[184:187], v44, s[36:39], s59 offen offset:0 sc1
Lcs_27:
    s_mov_b64 exec, s[78:79]
    s_cbranch_execz Lcs_28
    buffer_load_dwordx4 v[172:175], v44, s[36:39], s58 offen offset:1024 sc1
    buffer_load_dwordx4 v[188:191], v44, s[36:39], s59 offen offset:1024 sc1
Lcs_28:
    s_mov_b64 exec, -1
    s_branch Ljoin_26
Lglob_25:
    s_xor_b32 s58, s58, 16777216
    s_xor_b32 s59, s59, 16777216
    buffer_load_dwordx4 v[160:163], v8, s[36:39], s58 offen sc1
    buffer_load_dwordx4 v[176:179], v8, s[36:39], s59 offen sc1
    s_mov_b32 exec_lo, 0xffffffff
    s_mov_b32 exec_hi, 0xffff
    buffer_load_dwordx4 v[164:167], v8, s[36:39], s58 offen offset:1024 sc1
    buffer_load_dwordx4 v[180:183], v8, s[36:39], s59 offen offset:1024 sc1
    s_mov_b64 exec, s[76:77]
    s_cbranch_execz Lcs_29
    buffer_load_dwordx4 v[168:171], v44, s[36:39], s58 offen offset:0 sc1
    buffer_load_dwordx4 v[184:187], v44, s[36:39], s59 offen offset:0 sc1
Lcs_29:
    s_mov_b64 exec, s[78:79]
    s_cbranch_execz Lcs_30
    buffer_load_dwordx4 v[172:175], v44, s[36:39], s58 offen offset:1024 sc1
    buffer_load_dwordx4 v[188:191], v44, s[36:39], s59 offen offset:1024 sc1
Lcs_30:
    s_mov_b64 exec, -1
    s_xor_b32 s58, s58, 16777216
    s_xor_b32 s59, s59, 16777216
Ljoin_26:
    s_waitcnt vmcnt(0)
    v_min_u32 v16, v161, v163
    v_min3_u32 v16, v16, v165, v167
    v_min3_u32 v16, v16, v169, v171
    v_min3_u32 v16, v16, v173, v175
    v_min3_u32 v16, v16, v177, v179
    v_min3_u32 v16, v16, v181, v183
    v_min3_u32 v16, v16, v185, v187
    v_min3_u32 v16, v16, v189, v191
    v_max_u32 v17, v161, v163
    v_max3_u32 v17, v17, v165, v167
    v_max3_u32 v17, v17, v169, v171
    v_max3_u32 v17, v17, v173, v175
    v_max3_u32 v17, v17, v177, v179
    v_max3_u32 v17, v17, v181, v183
    v_max3_u32 v17, v17, v185, v187
    v_max3_u32 v17, v17, v189, v191
    v_cmp_eq_u32 vcc, s68, v16
    v_cmp_eq_u32 s[98:99], s68, v17
    s_and_b64 vcc, vcc, s[98:99]
    s_cmp_eq_u64 vcc, exec
    s_nop 1
    s_cbranch_scc1 Ldone_22
    s_sub_u32 s69, s69, 1
    s_cmp_lg_u32 s69, 0
    s_cbranch_scc1 Lpoll_21
Ldone_22:
    v_add_f32 v160, v160, v168
    v_add_f32 v162, v162, v170
    v_add_f32 v164, v164, v172
    v_add_f32 v166, v166, v174
    v_add_f32 v176, v176, v184
    v_add_f32 v178, v178, v186
    v_add_f32 v180, v180, v188
    v_add_f32 v182, v182, v190
    v_cvt_pk_bf16_f32 v16, v160, v162
    v_cvt_pk_bf16_f32 v17, v164, v166
    v_lshlrev_b32 v144, 16, v16
    v_and_b32 v145, 0xffff0000, v16
    v_lshlrev_b32 v146, 16, v17
    v_and_b32 v147, 0xffff0000, v17
    v_pk_mul_f32 v[144:145], v[144:145], s[90:91]
    v_pk_mul_f32 v[146:147], v[146:147], s[90:91]
    v_exp_f32 v144, v144
    v_exp_f32 v145, v145
    v_exp_f32 v146, v146
    v_exp_f32 v147, v147
    v_cvt_pk_bf16_f32 v20, v176, v178
    v_cvt_pk_bf16_f32 v21, v180, v182
    v_pk_add_f32 v[144:145], v[144:145], s[92:93]
    v_pk_add_f32 v[146:147], v[146:147], s[92:93]
    v_rcp_f32 v144, v144
    v_rcp_f32 v145, v145
    v_rcp_f32 v146, v146
    v_rcp_f32 v147, v147
    v_lshlrev_b32 v152, 16, v20
    v_and_b32 v153, 0xffff0000, v20
    v_lshlrev_b32 v154, 16, v21
    v_and_b32 v155, 0xffff0000, v21
    v_cvt_pk_bf16_f32 v16, v144, v145
    v_cvt_pk_bf16_f32 v17, v146, v147
    v_lshlrev_b32 v144, 16, v16
    v_and_b32 v145, 0xffff0000, v16
    v_lshlrev_b32 v146, 16, v17
    v_and_b32 v147, 0xffff0000, v17
    v_pk_mul_f32 v[144:145], v[144:145], v[152:153]
    v_pk_mul_f32 v[146:147], v[146:147], v[154:155]
    v_cvt_pk_bf16_f32 v16, v144, v145
    ds_write_b32 v219, v16 offset:0
    v_cvt_pk_bf16_f32 v17, v146, v147
    ds_write_b32 v219, v17 offset:256
    s_waitcnt lgkmcnt(0)
    s_barrier
    ds_read_b128 v[112:115], v217 offset:0
    ds_read_b128 v[116:119], v217 offset:64
    ds_read_b128 v[120:123], v217 offset:128
    ds_read_b128 v[124:127], v217 offset:192
    ds_read_b128 v[128:131], v217 offset:256
    ds_read_b128 v[132:135], v217 offset:320
    ds_read_b128 v[136:139], v217 offset:384
    s_waitcnt lgkmcnt(6)
    v_mfma_f32_16x16x32_bf16 v[144:147], v[112:115], v[48:51], 0
    s_waitcnt lgkmcnt(5)
    v_mfma_f32_16x16x32_bf16 v[144:147], v[116:119], v[52:55], v[144:147]
    s_waitcnt lgkmcnt(4)
    v_mfma_f32_16x16x32_bf16 v[144:147], v[120:123], v[56:59], v[144:147]
    s_waitcnt lgkmcnt(3)
    v_mfma_f32_16x16x32_bf16 v[144:147], v[124:127], v[60:63], v[144:147]
    s_waitcnt lgkmcnt(2)
    v_mfma_f32_16x16x32_bf16 v[144:147], v[128:131], v[64:67], v[144:147]
    s_waitcnt lgkmcnt(1)
    v_mfma_f32_16x16x32_bf16 v[144:147], v[132:135], v[68:71], v[144:147]
    s_waitcnt lgkmcnt(0)
    v_mfma_f32_16x16x32_bf16 v[144:147], v[136:139], v[72:75], v[144:147]
    s_mov_b32 exec_lo, 0xffffffff
    s_mov_b32 exec_hi, 0x0
    s_nop 5
    ds_write_b32 v220, v144 offset:0
    ds_write_b32 v220, v145 offset:64
    ds_write_b32 v220, v146 offset:128
    ds_write_b32 v220, v147 offset:192
    s_mov_b64 exec, -1
    ds_read_b32 v32, v222
    ds_read_b32 v34, v222 offset:4
    s_waitcnt lgkmcnt(0)
    buffer_store_dwordx4 v[32:35], v42, s[36:39], s60 offen sc1
    s_cmp_lg_u32 s3, 0
    s_cbranch_scc1 L_fin
    s_waitcnt vmcnt(0)
    s_mov_b32 s69, 1048592
    buffer_load_dwordx4 v[160:163], v8, s[36:39], s61 offen offset:0 sc1
    buffer_load_dwordx4 v[164:167], v8, s[36:39], s61 offen offset:1024 sc1
    buffer_load_dwordx4 v[168:171], v8, s[36:39], s61 offen offset:2048 sc1
    buffer_load_dwordx4 v[172:175], v8, s[36:39], s61 offen offset:3072 sc1
    buffer_load_dwordx4 v[176:179], v8, s[36:39], s62 offen offset:0 sc1
    buffer_load_dwordx4 v[180:183], v8, s[36:39], s62 offen offset:1024 sc1
    buffer_load_dwordx4 v[184:187], v8, s[36:39], s62 offen offset:2048 sc1
    buffer_load_dwordx4 v[188:191], v8, s[36:39], s62 offen offset:3072 sc1
    s_waitcnt vmcnt(0)
    v_min_u32 v16, v161, v163
    v_min3_u32 v16, v16, v165, v167
    v_min3_u32 v16, v16, v169, v171
    v_min3_u32 v16, v16, v173, v175
    v_min3_u32 v16, v16, v177, v179
    v_min3_u32 v16, v16, v181, v183
    v_min3_u32 v16, v16, v185, v187
    v_min3_u32 v16, v16, v189, v191
    v_max_u32 v17, v161, v163
    v_max3_u32 v17, v17, v165, v167
    v_max3_u32 v17, v17, v169, v171
    v_max3_u32 v17, v17, v173, v175
    v_max3_u32 v17, v17, v177, v179
    v_max3_u32 v17, v17, v181, v183
    v_max3_u32 v17, v17, v185, v187
    v_max3_u32 v17, v17, v189, v191
    v_cmp_eq_u32 vcc, s68, v16
    v_cmp_eq_u32 s[98:99], s68, v17
    s_and_b64 vcc, vcc, s[98:99]
    s_cmp_eq_u64 vcc, exec
    s_nop 1
    s_cbranch_scc1 Ldone_32
    s_sub_u32 s69, s69, 1
Lpoll_31:
    buffer_load_dwordx4 v[160:163], v8, s[36:39], s61 offen offset:0 sc1
    buffer_load_dwordx4 v[164:167], v8, s[36:39], s61 offen offset:1024 sc1
    buffer_load_dwordx4 v[168:171], v8, s[36:39], s61 offen offset:2048 sc1
    buffer_load_dwordx4 v[172:175], v8, s[36:39], s61 offen offset:3072 sc1
    buffer_load_dwordx4 v[176:179], v8, s[36:39], s62 offen offset:0 sc1
    buffer_load_dwordx4 v[180:183], v8, s[36:39], s62 offen offset:1024 sc1
    buffer_load_dwordx4 v[184:187], v8, s[36:39], s62 offen offset:2048 sc1
    buffer_load_dwordx4 v[188:191], v8, s[36:39], s62 offen offset:3072 sc1
    s_waitcnt vmcnt(0)
    v_min_u32 v16, v161, v163
    v_min3_u32 v16, v16, v165, v167
    v_min3_u32 v16, v16, v169, v171
    v_min3_u32 v16, v16, v173, v175
    v_min3_u32 v16, v16, v177, v179
    v_min3_u32 v16, v16, v181, v183
    v_min3_u32 v16, v16, v185, v187
    v_min3_u32 v16, v16, v189, v191
    v_max_u32 v17, v161, v163
    v_max3_u32 v17, v17, v165, v167
    v_max3_u32 v17, v17, v169, v171
    v_max3_u32 v17, v17, v173, v175
    v_max3_u32 v17, v17, v177, v179
    v_max3_u32 v17, v17, v181, v183
    v_max3_u32 v17, v17, v185, v187
    v_max3_u32 v17, v17, v189, v191
    v_cmp_eq_u32 vcc, s68, v16
    v_cmp_eq_u32 s[98:99], s68, v17
    s_and_b64 vcc, vcc, s[98:99]
    s_cmp_eq_u64 vcc, exec
    s_nop 1
    s_cbranch_scc1 Ldone_32
    s_sub_u32 s69, s69, 1
    s_cmp_lg_u32 s69, 0
    s_cbranch_scc1 Lpoll_31
Ldone_32:
    v_add_f32 v18, v160, v164
    v_add_f32 v20, v168, v172
    v_add_f32 v22, v176, v180
    v_add_f32 v24, v184, v188
    v_add_f32 v19, v162, v166
    v_add_f32 v21, v170, v174
    v_add_f32 v23, v178, v182
    v_add_f32 v25, v186, v190
    v_add_f32 v18, v18, v20
    v_add_f32 v22, v22, v24
    v_add_f32 v19, v19, v21
    v_add_f32 v23, v23, v25
    v_add_f32 v18, v18, v22
    v_add_f32 v19, v19, v23
    s_nop 0
    v_permlane32_swap_b32 v18, v20
    v_permlane32_swap_b32 v19, v21
    v_add_f32 v18, v18, v20
    v_add_f32 v19, v19, v21
    v_cvt_pk_bf16_f32 v16, v18, v19
    v_lshlrev_b32 v18, 16, v16
    v_and_b32 v19, 0xffff0000, v16
    v_add_f32 v18, v18, v10
    v_add_f32 v19, v19, v11
    v_cvt_pk_bf16_f32 v16, v18, v19
    s_mov_b32 exec_lo, 0xffffffff
    s_mov_b32 exec_hi, 0x0
    buffer_store_dword v16, v13, s[32:35], s40 offen
    s_mov_b64 exec, -1
    s_branch L_fin
L_roleq:
    s_cmp_lt_u32 s71, 14
    s_cbranch_scc1 L_roleq2
    s_mov_b32 s69, 1048592
    s_mov_b32 s66, 0
    buffer_load_dwordx4 v[192:195], v211, s[36:39], s56 offen sc1
    s_waitcnt vmcnt(0)
    v_min_u32 v16, v193, v195
    v_max_u32 v17, v193, v195
    v_cmp_eq_u32 vcc, s68, v16
    v_cmp_eq_u32 s[98:99], s68, v17
    s_and_b64 vcc, vcc, s[98:99]
    s_cmp_eq_u64 vcc, exec
    s_nop 1
    s_cbranch_scc1 Ldone_34
    s_sub_u32 s69, s69, 1
Lpoll_33:
    s_cmp_lg_u32 s69, 1048580
    s_cbranch_scc1 Ldf_35
    s_mov_b32 exec_lo, 0xffffffff
    s_mov_b32 exec_hi, 0x0
    buffer_store_dwordx4 v[32:35], v44, s[36:39], s49 offen sc1
    s_mov_b64 exec, -1
    s_cmp_eq_u32 s3, 0
    s_cbranch_scc0 Lml_36
    s_mov_b32 exec_lo, 0xff
    s_mov_b32 exec_hi, 0x0
    buffer_store_dwordx4 v[212:215], v209, s[36:39], s51 offen sc1
    s_mov_b64 exec, -1
Lml_36:
    s_mov_b32 s66, 1
Ldf_35:
    s_and_b32 s94, s69, 15
    s_cmp_eq_u32 s94, 0
    s_cbranch_scc1 Lglob_37
    buffer_load_dwordx4 v[192:195], v211, s[36:39], s56 offen sc1
    s_branch Ljoin_38
Lglob_37:
    s_xor_b32 s56, s56, 16777216
    buffer_load_dwordx4 v[192:195], v211, s[36:39], s56 offen sc1
    s_xor_b32 s56, s56, 16777216
Ljoin_38:
    s_waitcnt vmcnt(0)
    v_min_u32 v16, v193, v195
    v_max_u32 v17, v193, v195
    v_cmp_eq_u32 vcc, s68, v16
    v_cmp_eq_u32 s[98:99], s68, v17
    s_and_b64 vcc, vcc, s[98:99]
    s_cmp_eq_u64 vcc, exec
    s_nop 1
    s_cbranch_scc1 Ldone_34
    s_sub_u32 s69, s69, 1
    s_cmp_lg_u32 s69, 0
    s_cbranch_scc1 Lpoll_33
Ldone_34:
    s_mov_b32 s67, s66
    s_mov_b32 s69, 1048592
    s_mov_b32 s66, 0
    buffer_load_dwordx4 v[160:163], v8, s[36:39], s52 offen offset:0 sc1
    buffer_load_dwordx4 v[164:167], v8, s[36:39], s52 offen offset:1024 sc1
    buffer_load_dwordx4 v[168:171], v8, s[36:39], s52 offen offset:2048 sc1
    buffer_load_dwordx4 v[172:175], v8, s[36:39], s52 offen offset:3072 sc1
    buffer_load_dwordx4 v[176:179], v8, s[36:39], s55 offen offset:0 sc1
    buffer_load_dwordx4 v[180:183], v8, s[36:39], s55 offen offset:1024 sc1
    buffer_load_dwordx4 v[184:187], v8, s[36:39], s55 offen offset:2048 sc1
    buffer_load_dwordx4 v[188:191], v8, s[36:39], s55 offen offset:3072 sc1
    v_max_f32_dpp v18, v192, v192 quad_perm:[1,0,3,2] row_mask:0xf bank_mask:0xf
    s_nop 1
    v_max_f32_dpp v18, v18, v18 quad_perm:[2,3,0,1] row_mask:0xf bank_mask:0xf
    s_nop 1
    v_max_f32_dpp v18, v18, v18 row_half_mirror row_mask:0xf bank_mask:0xf
    v_sub_f32 v20, v192, v18
    v_mul_f32 v20, 0x3fb8aa3b, v20
    v_exp_f32 v20, v20
    s_nop 0
    v_mul_f32 v19, v20, v194
    s_nop 1
    v_add_f32_dpp v19, v19, v19 quad_perm:[1,0,3,2] row_mask:0xf bank_mask:0xf
    s_nop 1
    v_add_f32_dpp v19, v19, v19 quad_perm:[2,3,0,1] row_mask:0xf bank_mask:0xf
    s_nop 1
    v_add_f32_dpp v19, v19, v19 row_half_mirror row_mask:0xf bank_mask:0xf
    v_rcp_f32 v19, v19
    s_nop 0
    v_mul_f32 v20, v20, v19
    s_waitcnt vmcnt(0)
    v_min_u32 v28, v161, v163
    v_min3_u32 v28, v28, v165, v167
    v_min3_u32 v28, v28, v169, v171
    v_min3_u32 v28, v28, v173, v175
    v_min3_u32 v28, v28, v177, v179
    v_min3_u32 v28, v28, v181, v183
    v_min3_u32 v28, v28, v185, v187
    v_min3_u32 v28, v28, v189, v191
    v_max_u32 v29, v161, v163
    v_max3_u32 v29, v29, v165, v167
    v_max3_u32 v29, v29, v169, v171
    v_max3_u32 v29, v29, v173, v175
    v_max3_u32 v29, v29, v177, v179
    v_max3_u32 v29, v29, v181, v183
    v_max3_u32 v29, v29, v185, v187
    v_max3_u32 v29, v29, v189, v191
    v_cmp_eq_u32 vcc, s68, v28
    v_cmp_eq_u32 s[98:99], s68, v29
    s_and_b64 vcc, vcc, s[98:99]
    s_cmp_eq_u64 vcc, exec
    s_nop 1
    s_cbranch_scc1 Ldone_40
    s_sub_u32 s69, s69, 1
Lpoll_39:
    s_cmp_lg_u32 s69, 1048588
    s_cbranch_scc1 Ldf_41
    s_cmp_eq_u32 s67, 1
    s_cbranch_scc1 Ldef2_42
    s_mov_b32 exec_lo, 0xffffffff
    s_mov_b32 exec_hi, 0x0
    buffer_store_dwordx4 v[32:35], v44, s[36:39], s49 offen sc1
    s_mov_b64 exec, -1
    s_cmp_eq_u32 s3, 0
    s_cbranch_scc0 Lml_43
    s_mov_b32 exec_lo, 0xff
    s_mov_b32 exec_hi, 0x0
    buffer_store_dwordx4 v[212:215], v209, s[36:39], s51 offen sc1
    s_mov_b64 exec, -1
Lml_43:
    s_mov_b32 s67, 1
Ldef2_42:
    s_mov_b32 s66, 1
Ldf_41:
    s_and_b32 s94, s69, 15
    s_cmp_eq_u32 s94, 0
    s_cbranch_scc1 Lglob_44
    buffer_load_dwordx4 v[160:163], v8, s[36:39], s52 offen offset:0 sc1
    buffer_load_dwordx4 v[164:167], v8, s[36:39], s52 offen offset:1024 sc1
    buffer_load_dwordx4 v[168:171], v8, s[36:39], s52 offen offset:2048 sc1
    buffer_load_dwordx4 v[172:175], v8, s[36:39], s52 offen offset:3072 sc1
    buffer_load_dwordx4 v[176:179], v8, s[36:39], s55 offen offset:0 sc1
    buffer_load_dwordx4 v[180:183], v8, s[36:39], s55 offen offset:1024 sc1
    buffer_load_dwordx4 v[184:187], v8, s[36:39], s55 offen offset:2048 sc1
    buffer_load_dwordx4 v[188:191], v8, s[36:39], s55 offen offset:3072 sc1
    s_branch Ljoin_45
Lglob_44:
    s_xor_b32 s52, s52, 16777216
    s_xor_b32 s55, s55, 16777216
    buffer_load_dwordx4 v[160:163], v8, s[36:39], s52 offen offset:0 sc1
    buffer_load_dwordx4 v[164:167], v8, s[36:39], s52 offen offset:1024 sc1
    buffer_load_dwordx4 v[168:171], v8, s[36:39], s52 offen offset:2048 sc1
    buffer_load_dwordx4 v[172:175], v8, s[36:39], s52 offen offset:3072 sc1
    buffer_load_dwordx4 v[176:179], v8, s[36:39], s55 offen offset:0 sc1
    buffer_load_dwordx4 v[180:183], v8, s[36:39], s55 offen offset:1024 sc1
    buffer_load_dwordx4 v[184:187], v8, s[36:39], s55 offen offset:2048 sc1
    buffer_load_dwordx4 v[188:191], v8, s[36:39], s55 offen offset:3072 sc1
    s_xor_b32 s52, s52, 16777216
    s_xor_b32 s55, s55, 16777216
Ljoin_45:
    s_waitcnt vmcnt(0)
    v_min_u32 v28, v161, v163
    v_min3_u32 v28, v28, v165, v167
    v_min3_u32 v28, v28, v169, v171
    v_min3_u32 v28, v28, v173, v175
    v_min3_u32 v28, v28, v177, v179
    v_min3_u32 v28, v28, v181, v183
    v_min3_u32 v28, v28, v185, v187
    v_min3_u32 v28, v28, v189, v191
    v_max_u32 v29, v161, v163
    v_max3_u32 v29, v29, v165, v167
    v_max3_u32 v29, v29, v169, v171
    v_max3_u32 v29, v29, v173, v175
    v_max3_u32 v29, v29, v177, v179
    v_max3_u32 v29, v29, v181, v183
    v_max3_u32 v29, v29, v185, v187
    v_max3_u32 v29, v29, v189, v191
    v_cmp_eq_u32 vcc, s68, v28
    v_cmp_eq_u32 s[98:99], s68, v29
    s_and_b64 vcc, vcc, s[98:99]
    s_cmp_eq_u64 vcc, exec
    s_nop 1
    s_cbranch_scc1 Ldone_40
    s_sub_u32 s69, s69, 1
    s_cmp_lg_u32 s69, 0
    s_cbranch_scc1 Lpoll_39
Ldone_40:
    v_readlane_b32 s76, v20, 0
    v_readlane_b32 s77, v20, 1
    v_readlane_b32 s78, v20, 2
    v_readlane_b32 s79, v20, 3
    v_readlane_b32 s80, v20, 4
    v_readlane_b32 s81, v20, 5
    v_readlane_b32 s82, v20, 6
    v_readlane_b32 s83, v20, 7
    v_lshlrev_b32 v22, 16, v160
    v_mul_f32 v24, s76, v22
    v_lshlrev_b32 v23, 16, v162
    v_mul_f32 v25, s76, v23
    v_lshlrev_b32 v22, 16, v164
    v_fmac_f32 v24, s77, v22
    v_lshlrev_b32 v23, 16, v166
    v_fmac_f32 v25, s77, v23
    v_lshlrev_b32 v22, 16, v168
    v_fmac_f32 v24, s78, v22
    v_lshlrev_b32 v23, 16, v170
    v_fmac_f32 v25, s78, v23
    v_lshlrev_b32 v22, 16, v172
    v_fmac_f32 v24, s79, v22
    v_lshlrev_b32 v23, 16, v174
    v_fmac_f32 v25, s79, v23
    v_lshlrev_b32 v22, 16, v176
    v_fmac_f32 v24, s80, v22
    v_lshlrev_b32 v23, 16, v178
    v_fmac_f32 v25, s80, v23
    v_lshlrev_b32 v22, 16, v180
    v_fmac_f32 v24, s81, v22
    v_lshlrev_b32 v23, 16, v182
    v_fmac_f32 v25, s81, v23
    v_lshlrev_b32 v22, 16, v184
    v_fmac_f32 v24, s82, v22
    v_lshlrev_b32 v23, 16, v186
    v_fmac_f32 v25, s82, v23
    v_lshlrev_b32 v22, 16, v188
    v_fmac_f32 v24, s83, v22
    v_lshlrev_b32 v23, 16, v190
    v_fmac_f32 v25, s83, v23
    v_cvt_pk_bf16_f32 v26, v24, v25
    v_mov_b32 v27, v9
    buffer_store_dwordx2 v[26:27], v12, s[36:39], s57 offen offset:0 sc1
    v_readlane_b32 s76, v20, 8
    v_readlane_b32 s77, v20, 9
    v_readlane_b32 s78, v20, 10
    v_readlane_b32 s79, v20, 11
    v_readlane_b32 s80, v20, 12
    v_readlane_b32 s81, v20, 13
    v_readlane_b32 s82, v20, 14
    v_readlane_b32 s83, v20, 15
    v_and_b32 v22, 0xffff0000, v160
    v_mul_f32 v24, s76, v22
    v_and_b32 v23, 0xffff0000, v162
    v_mul_f32 v25, s76, v23
    v_and_b32 v22, 0xffff0000, v164
    v_fmac_f32 v24, s77, v22
    v_and_b32 v23, 0xffff0000, v166
    v_fmac_f32 v25, s77, v23
    v_and_b32 v22, 0xffff0000, v168
    v_fmac_f32 v24, s78, v22
    v_and_b32 v23, 0xffff0000, v170
    v_fmac_f32 v25, s78, v23
    v_and_b32 v22, 0xffff0000, v172
    v_fmac_f32 v24, s79, v22
    v_and_b32 v23, 0xffff0000, v174
    v_fmac_f32 v25, s79, v23
    v_and_b32 v22, 0xffff0000, v176
    v_fmac_f32 v24, s80, v22
    v_and_b32 v23, 0xffff0000, v178
    v_fmac_f32 v25, s80, v23
    v_and_b32 v22, 0xffff0000, v180
    v_fmac_f32 v24, s81, v22
    v_and_b32 v23, 0xffff0000, v182
    v_fmac_f32 v25, s81, v23
    v_and_b32 v22, 0xffff0000, v184
    v_fmac_f32 v24, s82, v22
    v_and_b32 v23, 0xffff0000, v186
    v_fmac_f32 v25, s82, v23
    v_and_b32 v22, 0xffff0000, v188
    v_fmac_f32 v24, s83, v22
    v_and_b32 v23, 0xffff0000, v190
    v_fmac_f32 v25, s83, v23
    v_cvt_pk_bf16_f32 v28, v24, v25
    v_mov_b32 v29, v9
    buffer_store_dwordx2 v[28:29], v12, s[36:39], s57 offen offset:512 sc1
    s_cmp_eq_u32 s67, 1
    s_cbranch_scc1 Ldef2_46
    s_mov_b32 exec_lo, 0xffffffff
    s_mov_b32 exec_hi, 0x0
    buffer_store_dwordx4 v[32:35], v44, s[36:39], s49 offen sc1
    s_mov_b64 exec, -1
    s_cmp_eq_u32 s3, 0
    s_cbranch_scc0 Lml_47
    s_mov_b32 exec_lo, 0xff
    s_mov_b32 exec_hi, 0x0
    buffer_store_dwordx4 v[212:215], v209, s[36:39], s51 offen sc1
    s_mov_b64 exec, -1
Lml_47:
    s_mov_b32 s67, 1
Ldef2_46:
    s_barrier
    s_lshl_b32 s55, s3, 12
    s_add_u32 s55, s55, 3211264
    s_mov_b32 s64, 12
    s_cmp_lt_u32 s75, 7
    s_cselect_b32 s26, 7340032, 0
    s_branch L_qcommon
L_roleq2:
    s_mov_b32 exec_lo, 0xffffffff
    s_mov_b32 exec_hi, 0x0
    buffer_store_dwordx4 v[32:35], v44, s[36:39], s49 offen sc1
    s_mov_b64 exec, -1
    s_cmp_eq_u32 s3, 0
    s_cbranch_scc0 Lml_48
    s_mov_b32 exec_lo, 0xff
    s_mov_b32 exec_hi, 0x0
    buffer_store_dwordx4 v[212:215], v209, s[36:39], s51 offen sc1
    s_mov_b64 exec, -1
Lml_48:
L_qcommon:
Lrest_49:
    s_cmp_ge_u32 s64, s58
    s_cbranch_scc1 Lrestd_50
    s_lshl_b32 s84, s64, 13
    s_add_u32 s84, s84, 98304
    s_and_b32 s84, s84, 0x1ffff
    s_add_u32 m0, s84, s73
    s_mul_i32 s84, s64, s65
    s_add_u32 s84, s84, s74
    buffer_load_dwordx4 v6, s[24:27], s84 offen nt lds
    s_add_u32 s64, s64, 1
    s_branch Lrest_49
Lrestd_50:
    s_mov_b32 exec_lo, 0xffffffff
    s_mov_b32 exec_hi, 0x0
    buffer_load_dwordx4 v[176:179], v41, s[36:39], s53 offen sc1
    s_mov_b64 exec, -1
    s_waitcnt vmcnt(1)
    s_barrier
    s_bitcmp1_b32 s59, 0
    s_cbranch_scc0 Lz_51
    v_add_u32 v30, 98304, v15
    ds_read_b64_tr_b16 v[48:49], v30 offset:0
    ds_read_b64_tr_b16 v[50:51], v30 offset:512
    ds_read_b64_tr_b16 v[52:53], v30 offset:8192
    ds_read_b64_tr_b16 v[54:55], v30 offset:8704
    ds_read_b64_tr_b16 v[56:57], v30 offset:16384
    ds_read_b64_tr_b16 v[58:59], v30 offset:16896
    ds_read_b64_tr_b16 v[60:61], v30 offset:24576
    ds_read_b64_tr_b16 v[62:63], v30 offset:25088
    s_waitcnt lgkmcnt(4)
    s_branch Lzd_52
Lz_51:
    v_mov_b32 v48, 0
    v_mov_b32 v49, 0
    v_mov_b32 v50, 0
    v_mov_b32 v51, 0
    v_mov_b32 v52, 0
    v_mov_b32 v53, 0
    v_mov_b32 v54, 0
    v_mov_b32 v55, 0
    v_mov_b32 v56, 0
    v_mov_b32 v57, 0
    v_mov_b32 v58, 0
    v_mov_b32 v59, 0
    v_mov_b32 v60, 0
    v_mov_b32 v61, 0
    v_mov_b32 v62, 0
    v_mov_b32 v63, 0
Lzd_52:
    s_bitcmp1_b32 s59, 1
    s_cbranch_scc0 Lz_53
    v_add_u32 v30, 0, v15
    ds_read_b64_tr_b16 v[64:65], v30 offset:0
    ds_read_b64_tr_b16 v[66:67], v30 offset:512
    ds_read_b64_tr_b16 v[68:69], v30 offset:8192
    ds_read_b64_tr_b16 v[70:71], v30 offset:8704
    ds_read_b64_tr_b16 v[72:73], v30 offset:16384
    ds_read_b64_tr_b16 v[74:75], v30 offset:16896
    ds_read_b64_tr_b16 v[76:77], v30 offset:24576
    ds_read_b64_tr_b16 v[78:79], v30 offset:25088
    s_waitcnt lgkmcnt(4)
    s_branch Lzd_54
Lz_53:
    v_mov_b32 v64, 0
    v_mov_b32 v65, 0
    v_mov_b32 v66, 0
    v_mov_b32 v67, 0
    v_mov_b32 v68, 0
    v_mov_b32 v69, 0
    v_mov_b32 v70, 0
    v_mov_b32 v71, 0
    v_mov_b32 v72, 0
    v_mov_b32 v73, 0
    v_mov_b32 v74, 0
    v_mov_b32 v75, 0
    v_mov_b32 v76, 0
    v_mov_b32 v77, 0
    v_mov_b32 v78, 0
    v_mov_b32 v79, 0
Lzd_54:
    s_bitcmp1_b32 s59, 2
    s_cbranch_scc0 Lz_55
    v_add_u32 v30, 32768, v15
    ds_read_b64_tr_b16 v[80:81], v30 offset:0
    ds_read_b64_tr_b16 v[82:83], v30 offset:512
    ds_read_b64_tr_b16 v[84:85], v30 offset:8192
    ds_read_b64_tr_b16 v[86:87], v30 offset:8704
    ds_read_b64_tr_b16 v[88:89], v30 offset:16384
    ds_read_b64_tr_b16 v[90:91], v30 offset:16896
    ds_read_b64_tr_b16 v[92:93], v30 offset:24576
    ds_read_b64_tr_b16 v[94:95], v30 offset:25088
    s_waitcnt lgkmcnt(4)
    s_branch Lzd_56
Lz_55:
    v_mov_b32 v80, 0
    v_mov_b32 v81, 0
    v_mov_b32 v82, 0
    v_mov_b32 v83, 0
    v_mov_b32 v84, 0
    v_mov_b32 v85, 0
    v_mov_b32 v86, 0
    v_mov_b32 v87, 0
    v_mov_b32 v88, 0
    v_mov_b32 v89, 0
    v_mov_b32 v90, 0
    v_mov_b32 v91, 0
    v_mov_b32 v92, 0
    v_mov_b32 v93, 0
    v_mov_b32 v94, 0
    v_mov_b32 v95, 0
Lzd_56:
    s_bitcmp1_b32 s59, 3
    s_cbranch_scc0 Lz_57
    v_add_u32 v30, 65536, v15
    ds_read_b64_tr_b16 v[96:97], v30 offset:0
    ds_read_b64_tr_b16 v[98:99], v30 offset:512
    ds_read_b64_tr_b16 v[100:101], v30 offset:8192
    ds_read_b64_tr_b16 v[102:103], v30 offset:8704
    ds_read_b64_tr_b16 v[104:105], v30 offset:16384
    ds_read_b64_tr_b16 v[106:107], v30 offset:16896
    ds_read_b64_tr_b16 v[108:109], v30 offset:24576
    ds_read_b64_tr_b16 v[110:111], v30 offset:25088
    s_waitcnt lgkmcnt(4)
    s_branch Lzd_58
Lz_57:
    v_mov_b32 v96, 0
    v_mov_b32 v97, 0
    v_mov_b32 v98, 0
    v_mov_b32 v99, 0
    v_mov_b32 v100, 0
    v_mov_b32 v101, 0
    v_mov_b32 v102, 0
    v_mov_b32 v103, 0
    v_mov_b32 v104, 0
    v_mov_b32 v105, 0
    v_mov_b32 v106, 0
    v_mov_b32 v107, 0
    v_mov_b32 v108, 0
    v_mov_b32 v109, 0
    v_mov_b32 v110, 0
    v_mov_b32 v111, 0
Lzd_58:
    s_mov_b32 s69, 1048592
    buffer_load_dwordx4 v[160:163], v8, s[36:39], s55 offen offset:0 sc1
    buffer_load_dwordx4 v[164:167], v8, s[36:39], s55 offen offset:1024 sc1
    buffer_load_dwordx4 v[168:171], v8, s[36:39], s55 offen offset:2048 sc1
    buffer_load_dwordx4 v[172:175], v8, s[36:39], s55 offen offset:3072 sc1
    s_waitcnt vmcnt(0)
    v_min_u32 v16, v161, v163
    v_min3_u32 v16, v16, v165, v167
    v_min3_u32 v16, v16, v169, v171
    v_min3_u32 v16, v16, v173, v175
    v_max_u32 v17, v161, v163
    v_max3_u32 v17, v17, v165, v167
    v_max3_u32 v17, v17, v169, v171
    v_max3_u32 v17, v17, v173, v175
    v_cmp_eq_u32 vcc, s68, v16
    v_cmp_eq_u32 s[98:99], s68, v17
    s_and_b64 vcc, vcc, s[98:99]
    s_cmp_eq_u64 vcc, exec
    s_nop 1
    s_cbranch_scc1 Ldone_60
    s_sub_u32 s69, s69, 1
Lpoll_59:
    buffer_load_dwordx4 v[160:163], v8, s[36:39], s55 offen offset:0 sc1
    buffer_load_dwordx4 v[164:167], v8, s[36:39], s55 offen offset:1024 sc1
    buffer_load_dwordx4 v[168:171], v8, s[36:39], s55 offen offset:2048 sc1
    buffer_load_dwordx4 v[172:175], v8, s[36:39], s55 offen offset:3072 sc1
    s_waitcnt vmcnt(0)
    v_min_u32 v16, v161, v163
    v_min3_u32 v16, v16, v165, v167
    v_min3_u32 v16, v16, v169, v171
    v_min3_u32 v16, v16, v173, v175
    v_max_u32 v17, v161, v163
    v_max3_u32 v17, v17, v165, v167
    v_max3_u32 v17, v17, v169, v171
    v_max3_u32 v17, v17, v173, v175
    v_cmp_eq_u32 vcc, s68, v16
    v_cmp_eq_u32 s[98:99], s68, v17
    s_and_b64 vcc, vcc, s[98:99]
    s_cmp_eq_u64 vcc, exec
    s_nop 1
    s_cbranch_scc1 Ldone_60
    s_sub_u32 s69, s69, 1
    s_cmp_lg_u32 s69, 0
    s_cbranch_scc1 Lpoll_59
Ldone_60:
    v_lshlrev_b32 v144, 16, v160
    v_and_b32 v145, 0xffff0000, v160
    v_readfirstlane_b32 s86, v144
    v_lshlrev_b32 v146, 16, v162
    v_and_b32 v147, 0xffff0000, v162
    v_lshlrev_b32 v148, 16, v164
    v_and_b32 v149, 0xffff0000, v164
    v_lshlrev_b32 v150, 16, v166
    v_and_b32 v151, 0xffff0000, v166
    v_lshlrev_b32 v152, 16, v168
    v_and_b32 v153, 0xffff0000, v168
    v_lshlrev_b32 v154, 16, v170
    v_and_b32 v155, 0xffff0000, v170
    v_lshlrev_b32 v156, 16, v172
    v_and_b32 v157, 0xffff0000, v172
    v_lshlrev_b32 v158, 16, v174
    v_and_b32 v159, 0xffff0000, v174
    s_mov_b32 s87, s86
    v_pk_add_f32 v[16:17], v[144:145], s[86:87] neg_lo:[0,1] neg_hi:[0,1]
    v_pk_mul_f32 v[20:21], v[16:17], v[16:17]
    v_pk_add_f32 v[18:19], v[146:147], s[86:87] neg_lo:[0,1] neg_hi:[0,1]
    v_pk_mul_f32 v[22:23], v[18:19], v[18:19]
    v_pk_add_f32 v[24:25], v[148:149], s[86:87] neg_lo:[0,1] neg_hi:[0,1]
    v_pk_add_f32 v[16:17], v[16:17], v[24:25]
    v_pk_fma_f32 v[20:21], v[24:25], v[24:25], v[20:21]
    v_pk_add_f32 v[26:27], v[150:151], s[86:87] neg_lo:[0,1] neg_hi:[0,1]
    v_pk_add_f32 v[18:19], v[18:19], v[26:27]
    v_pk_fma_f32 v[22:23], v[26:27], v[26:27], v[22:23]
    v_pk_add_f32 v[24:25], v[152:153], s[86:87] neg_lo:[0,1] neg_hi:[0,1]
    v_pk_add_f32 v[16:17], v[16:17], v[24:25]
    v_pk_fma_f32 v[20:21], v[24:25], v[24:25], v[20:21]
    v_pk_add_f32 v[26:27], v[154:155], s[86:87] neg_lo:[0,1] neg_hi:[0,1]
    v_pk_add_f32 v[18:19], v[18:19], v[26:27]
    v_pk_fma_f32 v[22:23], v[26:27], v[26:27], v[22:23]
    v_pk_add_f32 v[24:25], v[156:157], s[86:87] neg_lo:[0,1] neg_hi:[0,1]
    v_pk_add_f32 v[16:17], v[16:17], v[24:25]
    v_pk_fma_f32 v[20:21], v[24:25], v[24:25], v[20:21]
    v_pk_add_f32 v[26:27], v[158:159], s[86:87] neg_lo:[0,1] neg_hi:[0,1]
    v_pk_add_f32 v[18:19], v[18:19], v[26:27]
    v_pk_fma_f32 v[22:23], v[26:27], v[26:27], v[22:23]
    v_pk_add_f32 v[16:17], v[16:17], v[18:19]
    v_pk_add_f32 v[20:21], v[20:21], v[22:23]
    v_add_f32 v16, v16, v17
    v_add_f32 v20, v20, v21
    v_mov_b32 v18, 0x3a800000
    v_add_f32_dpp v16, v16, v16 row_shr:1 row_mask:0xf bank_mask:0xf bound_ctrl:0
    v_add_f32_dpp v20, v20, v20 row_shr:1 row_mask:0xf bank_mask:0xf bound_ctrl:0
    s_nop 0
    v_add_f32_dpp v16, v16, v16 row_shr:2 row_mask:0xf bank_mask:0xf bound_ctrl:0
    v_add_f32_dpp v20, v20, v20 row_shr:2 row_mask:0xf bank_mask:0xf bound_ctrl:0
    s_nop 0
    v_add_f32_dpp v16, v16, v16 row_shr:4 row_mask:0xf bank_mask:0xf bound_ctrl:0
    v_add_f32_dpp v20, v20, v20 row_shr:4 row_mask:0xf bank_mask:0xf bound_ctrl:0
    s_nop 0
    v_add_f32_dpp v16, v16, v16 row_shr:8 row_mask:0xf bank_mask:0xf bound_ctrl:0
    v_add_f32_dpp v20, v20, v20 row_shr:8 row_mask:0xf bank_mask:0xf bound_ctrl:0
    s_nop 0
    v_add_f32_dpp v16, v16, v16 row_bcast:15 row_mask:0xa bank_mask:0xf
    v_add_f32_dpp v20, v20, v20 row_bcast:15 row_mask:0xa bank_mask:0xf
    s_nop 0
    v_add_f32_dpp v16, v16, v16 row_bcast:31 row_mask:0xc bank_mask:0xf
    v_add_f32_dpp v20, v20, v20 row_bcast:31 row_mask:0xc bank_mask:0xf
    v_readlane_b32 s84, v16, 63
    v_readlane_b32 s85, v20, 63
    s_nop 0
    v_mul_f32 v16, s84, v18
    v_mul_f32 v20, s85, v18
    v_add_f32 v24, s86, v16
    v_fma_f32 v16, -v16, v16, v20
    v_max_f32 v16, 0, v16
    v_cvt_pk_bf16_f32 v16, v16, v16
    v_and_b32 v16, 0xffff0000, v16
    v_add_f32 v16, 0x3727c5ac, v16
    v_cvt_pk_bf16_f32 v16, v16, v16
    v_and_b32 v16, 0xffff0000, v16
    v_sqrt_f32 v16, v16
    v_cvt_pk_bf16_f32 v24, v24, v24
    v_and_b32 v24, 0xffff0000, v24
    v_cvt_pk_bf16_f32 v16, v16, v16
    v_and_b32 v16, 0xffff0000, v16
    v_rcp_f32 v16, v16
    v_mov_b32 v25, v24
    v_pk_add_f32 v[144:145], v[144:145], v[24:25] neg_lo:[0,1] neg_hi:[0,1]
    v_mov_b32 v17, v16
    v_cvt_pk_bf16_f32 v145, v144, v145
    v_lshlrev_b32 v144, 16, v145
    v_and_b32 v145, 0xffff0000, v145
    v_pk_mul_f32 v[144:145], v[144:145], v[16:17]
    v_cvt_pk_bf16_f32 v176, v144, v145
    v_pk_add_f32 v[146:147], v[146:147], v[24:25] neg_lo:[0,1] neg_hi:[0,1]
    v_cvt_pk_bf16_f32 v147, v146, v147
    v_lshlrev_b32 v146, 16, v147
    v_and_b32 v147, 0xffff0000, v147
    v_pk_mul_f32 v[146:147], v[146:147], v[16:17]
    v_cvt_pk_bf16_f32 v177, v146, v147
    v_pk_add_f32 v[148:149], v[148:149], v[24:25] neg_lo:[0,1] neg_hi:[0,1]
    v_cvt_pk_bf16_f32 v149, v148, v149
    v_lshlrev_b32 v148, 16, v149
    v_and_b32 v149, 0xffff0000, v149
    v_pk_mul_f32 v[148:149], v[148:149], v[16:17]
    v_cvt_pk_bf16_f32 v178, v148, v149
    v_pk_add_f32 v[150:151], v[150:151], v[24:25] neg_lo:[0,1] neg_hi:[0,1]
    v_cvt_pk_bf16_f32 v151, v150, v151
    v_lshlrev_b32 v150, 16, v151
    v_and_b32 v151, 0xffff0000, v151
    v_pk_mul_f32 v[150:151], v[150:151], v[16:17]
    v_cvt_pk_bf16_f32 v179, v150, v151
    v_pk_add_f32 v[152:153], v[152:153], v[24:25] neg_lo:[0,1] neg_hi:[0,1]
    v_cvt_pk_bf16_f32 v153, v152, v153
    v_lshlrev_b32 v152, 16, v153
    v_and_b32 v153, 0xffff0000, v153
    v_pk_mul_f32 v[152:153], v[152:153], v[16:17]
    v_cvt_pk_bf16_f32 v180, v152, v153
    v_pk_add_f32 v[154:155], v[154:155], v[24:25] neg_lo:[0,1] neg_hi:[0,1]
    v_cvt_pk_bf16_f32 v155, v154, v155
    v_lshlrev_b32 v154, 16, v155
    v_and_b32 v155, 0xffff0000, v155
    v_pk_mul_f32 v[154:155], v[154:155], v[16:17]
    v_cvt_pk_bf16_f32 v181, v154, v155
    v_pk_add_f32 v[156:157], v[156:157], v[24:25] neg_lo:[0,1] neg_hi:[0,1]
    v_cvt_pk_bf16_f32 v157, v156, v157
    v_lshlrev_b32 v156, 16, v157
    v_and_b32 v157, 0xffff0000, v157
    v_pk_mul_f32 v[156:157], v[156:157], v[16:17]
    v_cvt_pk_bf16_f32 v182, v156, v157
    v_pk_add_f32 v[158:159], v[158:159], v[24:25] neg_lo:[0,1] neg_hi:[0,1]
    v_cvt_pk_bf16_f32 v159, v158, v159
    v_lshlrev_b32 v158, 16, v159
    v_and_b32 v159, 0xffff0000, v159
    v_pk_mul_f32 v[158:159], v[158:159], v[16:17]
    v_cvt_pk_bf16_f32 v183, v158, v159
    ds_write_b64 v207, v[176:177] offset:0
    ds_write_b64 v207, v[178:179] offset:512
    ds_write_b64 v207, v[180:181] offset:1024
    ds_write_b64 v207, v[182:183] offset:1536
    s_waitcnt lgkmcnt(0)
    s_barrier
    ds_read_b128 v[112:115], v7 offset:0
    ds_read_b128 v[116:119], v7 offset:128
    ds_read_b128 v[120:123], v7 offset:256
    ds_read_b128 v[124:127], v7 offset:384
    ds_read_b128 v[128:131], v7 offset:512
    ds_read_b128 v[132:135], v7 offset:640
    ds_read_b128 v[136:139], v7 offset:768
    ds_read_b128 v[140:143], v7 offset:896
    s_waitcnt lgkmcnt(7)
    v_mfma_f32_16x16x32_bf16 v[144:147], v[112:115], v[48:51], 0
    ds_read_b128 v[112:115], v7 offset:1024
    s_waitcnt lgkmcnt(7)
    v_mfma_f32_16x16x32_bf16 v[144:147], v[116:119], v[52:55], v[144:147]
    ds_read_b128 v[116:119], v7 offset:1152
    s_waitcnt lgkmcnt(7)
    v_mfma_f32_16x16x32_bf16 v[144:147], v[120:123], v[56:59], v[144:147]
    ds_read_b128 v[120:123], v7 offset:1280
    s_waitcnt lgkmcnt(7)
    v_mfma_f32_16x16x32_bf16 v[144:147], v[124:127], v[60:63], v[144:147]
    ds_read_b128 v[124:127], v7 offset:1408
    s_waitcnt lgkmcnt(7)
    v_mfma_f32_16x16x32_bf16 v[144:147], v[128:131], v[64:67], v[144:147]
    ds_read_b128 v[128:131], v7 offset:1536
    s_waitcnt lgkmcnt(7)
    v_mfma_f32_16x16x32_bf16 v[144:147], v[132:135], v[68:71], v[144:147]
    ds_read_b128 v[132:135], v7 offset:1664
    s_waitcnt lgkmcnt(7)
    v_mfma_f32_16x16x32_bf16 v[144:147], v[136:139], v[72:75], v[144:147]
    ds_read_b128 v[136:139], v7 offset:1792
    s_waitcnt lgkmcnt(7)
    v_mfma_f32_16x16x32_bf16 v[144:147], v[140:143], v[76:79], v[144:147]
    ds_read_b128 v[140:143], v7 offset:1920
    s_waitcnt lgkmcnt(7)
    v_mfma_f32_16x16x32_bf16 v[144:147], v[112:115], v[80:83], v[144:147]
    s_waitcnt lgkmcnt(6)
    v_mfma_f32_16x16x32_bf16 v[144:147], v[116:119], v[84:87], v[144:147]
    s_waitcnt lgkmcnt(5)
    v_mfma_f32_16x16x32_bf16 v[144:147], v[120:123], v[88:91], v[144:147]
    s_waitcnt lgkmcnt(4)
    v_mfma_f32_16x16x32_bf16 v[144:147], v[124:127], v[92:95], v[144:147]
    s_waitcnt lgkmcnt(3)
    v_mfma_f32_16x16x32_bf16 v[144:147], v[128:131], v[96:99], v[144:147]
    s_waitcnt lgkmcnt(2)
    v_mfma_f32_16x16x32_bf16 v[144:147], v[132:135], v[100:103], v[144:147]
    s_waitcnt lgkmcnt(1)
    v_mfma_f32_16x16x32_bf16 v[144:147], v[136:139], v[104:107], v[144:147]
    s_waitcnt lgkmcnt(0)
    v_mfma_f32_16x16x32_bf16 v[144:147], v[140:143], v[108:111], v[144:147]
    s_nop 7
    v_permlane32_swap_b32 v144, v18
    v_permlane32_swap_b32 v145, v19
    v_permlane32_swap_b32 v146, v20
    v_permlane32_swap_b32 v147, v21
    v_add_f32_dpp v144, v18, v144 row_shl:8 row_mask:0xf bank_mask:0xf bound_ctrl:0
    v_add_f32_dpp v145, v19, v145 row_shl:8 row_mask:0xf bank_mask:0xf bound_ctrl:0
    v_add_f32_dpp v146, v20, v146 row_shl:8 row_mask:0xf bank_mask:0xf bound_ctrl:0
    v_add_f32_dpp v147, v21, v147 row_shl:8 row_mask:0xf bank_mask:0xf bound_ctrl:0
    s_mov_b32 exec_lo, 0xff00ff
    s_mov_b32 exec_hi, 0x0
    ds_write_b32 v221, v144 offset:0
    ds_write_b32 v221, v145 offset:32
    ds_write_b32 v221, v146 offset:64
    ds_write_b32 v221, v147 offset:96
    s_mov_b64 exec, -1
    ds_read_b32 v32, v222
    ds_read_b32 v34, v222 offset:4
    s_waitcnt lgkmcnt(0)
    s_mov_b32 exec_lo, 0xffffffff
    s_mov_b32 exec_hi, 0x0
    buffer_store_dwordx4 v[32:35], v41, s[36:39], s53 offen
    s_mov_b64 exec, -1
    s_barrier
    s_cmp_lg_u32 s3, 1
    s_cbranch_scc1 Lfl_61
    v_mov_b32 v18, v9
    v_mov_b32 v19, v9
    s_mov_b32 exec_lo, 0x1
    s_mov_b32 exec_hi, 0x0
    buffer_store_dwordx2 v[18:19], v12, s[36:39], s63 offen
    s_mov_b64 exec, -1
Lfl_61:
    s_mov_b32 exec_lo, 0xffffffff
    s_mov_b32 exec_hi, 0x0
    buffer_store_dwordx4 v[32:35], v41, s[36:39], s54 offen sc1
    s_mov_b64 exec, -1
    s_cmp_lg_u32 s2, 8
    s_cbranch_scc1 L_fin
    s_cmp_lg_u32 s3, 1
    s_cbranch_scc1 L_fin
    v_mov_b32 v16, 0
    s_mov_b32 exec_lo, 0x1
    s_mov_b32 exec_hi, 0x0
    buffer_store_dword v9, v16, s[36:39], 0 offen offset:0
    s_mov_b64 exec, -1
L_fin:
L_end:
    s_endpgm

.section .rodata,"a"
.p2align 6
.amdhsa_kernel sequential_preLN__sliding_block_cached__glu_gated_glu__decode_kernel
  .amdhsa_next_free_vgpr 224
  .amdhsa_next_free_sgpr 102
  .amdhsa_accum_offset 224
  .amdhsa_group_segment_fixed_size 0
  .amdhsa_kernarg_size 96
  .amdhsa_user_sgpr_count 2
  .amdhsa_user_sgpr_kernarg_segment_ptr 1
  .amdhsa_system_sgpr_workgroup_id_x 1
.end_amdhsa_kernel
```
